```python
import torch

def _softmax(x, axis=-1):
    return torch.softmax(x, dim=axis)
def _gelu(x):
    return torch.nn.functional.gelu(x, approximate="tanh")
def _silu(x):
    return torch.nn.functional.silu(x)
def _sigmoid(x):
    return torch.sigmoid(x)
def _layernorm(x, axis=-1, eps=1e-5):
    m = x.mean(dim=axis, keepdim=True)
    v = x.var(dim=axis, keepdim=True, unbiased=False)
    return (x - m) / torch.sqrt(v + eps)
def _scatter_add(tgt, idx, src, axis=0):
    return tgt.clone().index_add_(axis, idx, src)
def _segment_sum(src, seg, n):
    out = torch.zeros((n,) + src.shape[1:], dtype=src.dtype)
    return out.index_add_(0, seg, src)
def _pad(x, pw):
    flat = tuple(v for pair in reversed(pw) for v in pair)
    return torch.nn.functional.pad(x, flat)

kernel_name = 'concat_heads__gqa_block_cached__gqa_block_cached__decode'

def setup_inputs():

    _w = (lambda a: (lambda t: t.to(torch.bfloat16) if t.is_floating_point() else t)(torch.as_tensor(a)))
    def _A_setup():
        B, Sq, D = 8, 1, 448
        Hq, Hkv, Sk, Dh = 16, 8, 4096, 256
        assert Hq % Hkv == 0, (Hq, Hkv)
        return {
            "x": _w((lambda *s: torch.randn(*s, dtype=torch.bfloat16) * 0.8)(B, Sq, D)),
            "k_cache": _w((lambda *s: torch.randn(*s, dtype=torch.bfloat16) * 0.8)(B, Hkv, Sk, Dh)),
            "v_cache": _w((lambda *s: torch.randn(*s, dtype=torch.bfloat16) * 0.05)(B, Hkv, Sk, Dh)),
            "wq": _w((lambda *s: torch.randn(*s, dtype=torch.bfloat16) * 0.8)(D, Hq * Dh) * (D ** -0.5)),
            "wo": _w((lambda *s: torch.randn(*s, dtype=torch.bfloat16) * 0.05)(Hq * Dh, D) * ((Hq * Dh) ** -0.5)),
        }
    _A_in = _A_setup()

    def _B_setup():
        B, Sq, D = 8, 1, 448
        Hq, Hkv, Sk, Dh = 16, 8, 4096, 256
        assert Hq % Hkv == 0, (Hq, Hkv)
        return {
            "x": _w((lambda *s: torch.randn(*s, dtype=torch.bfloat16) * 0.8)(B, Sq, D)),
            "k_cache": _w((lambda *s: torch.randn(*s, dtype=torch.bfloat16) * 0.8)(B, Hkv, Sk, Dh)),
            "v_cache": _w((lambda *s: torch.randn(*s, dtype=torch.bfloat16) * 0.05)(B, Hkv, Sk, Dh)),
            "wq": _w((lambda *s: torch.randn(*s, dtype=torch.bfloat16) * 0.8)(D, Hq * Dh) * (D ** -0.5)),
            "wo": _w((lambda *s: torch.randn(*s, dtype=torch.bfloat16) * 0.05)(Hq * Dh, D) * ((Hq * Dh) ** -0.5)),
        }
    _B_in = _B_setup()

    return {
        "A_x": _A_in["x"],
        "A_k_cache": _A_in["k_cache"],
        "A_v_cache": _A_in["v_cache"],
        "A_wq": _A_in["wq"],
        "A_wo": _A_in["wo"],
        "B_x": _B_in["x"],
        "B_k_cache": _B_in["k_cache"],
        "B_v_cache": _B_in["v_cache"],
        "B_wq": _B_in["wq"],
        "B_wo": _B_in["wo"],
    }

def reference(A_x, A_k_cache, A_v_cache, A_wq, A_wo, B_x, B_k_cache, B_v_cache, B_wq, B_wo):
    def _A_ref(x, k_cache, v_cache, wq, wo):
        B, Sq, D = x.shape
        Hq, Dh = 16, 256
        Hkv = k_cache.shape[1]
        rep = Hq // Hkv
        q = (lambda x, *d: x.permute(*d))((x @ wq).reshape(B, Sq, Hq, Dh), 0, 2, 1, 3)
        k = (lambda x, n, axis: torch.repeat_interleave(x, n, dim=axis))(k_cache, rep, axis=1)
        v = (lambda x, n, axis: torch.repeat_interleave(x, n, dim=axis))(v_cache, rep, axis=1)
        scores = torch.einsum("bhqd,bhkd->bhqk", q, k) * (Dh ** -0.5)
        p = _softmax(scores, axis=-1)
        o = torch.einsum("bhqk,bhkd->bhqd", p, v)
        return (lambda x, *d: x.permute(*d))(o, 0, 2, 1, 3).reshape(B, Sq, Hq * Dh) @ wo

    def _B_ref(x, k_cache, v_cache, wq, wo):
        B, Sq, D = x.shape
        Hq, Dh = 16, 256
        Hkv = k_cache.shape[1]
        rep = Hq // Hkv
        q = (lambda x, *d: x.permute(*d))((x @ wq).reshape(B, Sq, Hq, Dh), 0, 2, 1, 3)
        k = (lambda x, n, axis: torch.repeat_interleave(x, n, dim=axis))(k_cache, rep, axis=1)
        v = (lambda x, n, axis: torch.repeat_interleave(x, n, dim=axis))(v_cache, rep, axis=1)
        scores = torch.einsum("bhqd,bhkd->bhqk", q, k) * (Dh ** -0.5)
        p = _softmax(scores, axis=-1)
        o = torch.einsum("bhqk,bhkd->bhqd", p, v)
        return (lambda x, *d: x.permute(*d))(o, 0, 2, 1, 3).reshape(B, Sq, Hq * Dh) @ wo

    a = _A_ref(A_x, A_k_cache, A_v_cache, A_wq, A_wo)
    b = _B_ref(B_x, B_k_cache, B_v_cache, B_wq, B_wo)
    return torch.concatenate([a, b], axis=-1)
```

```asm
; @launch grid=(256,1,1) block=(320,1,1) lds=98368
.amdgcn_target "amdgcn-amd-amdhsa--gfx950"
.text
.globl concat_heads__gqa_block_cached__gqa_block_cached__decode_kernel
.p2align 8
.type concat_heads__gqa_block_cached__gqa_block_cached__decode_kernel,@function
concat_heads__gqa_block_cached__gqa_block_cached__decode_kernel:
    s_load_dwordx16 s[56:71], s[0:1], 0
    s_load_dwordx8 s[32:39], s[0:1], 64
    s_load_dwordx2 s[12:13], s[0:1], 96
    s_cmp_ge_u32 s2, 256
    s_cbranch_scc1 L_end
    v_lshrrev_b32 v1, 6, v0
    s_and_b32 s42, s2, 7
    s_lshl_b32 s3, s42, 5
    s_lshr_b32 s40, s2, 3
    s_add_u32 s40, s40, s3
    v_readfirstlane_b32 s44, v1
    v_and_b32 v0, 63, v0
    s_bfe_u32 s43, s40, 0x30002
    s_and_b32 s3, s40, 3
    s_lshl_b32 s41, s42, 2
    s_or_b32 s41, s41, s3
    s_cmp_lg_u32 s44, 0
    s_cbranch_scc1 L_stream
    s_setprio 3
    v_lshrrev_b32 v7, 2, v0
    v_lshlrev_b32 v8, 13, v7
    v_and_b32 v45, 3, v0
    v_lshl_add_u32 v8, v45, 4, v8
    s_and_b32 s3, s41, 1
    s_lshl_b32 s46, s42, 1
    s_or_b32 s46, s46, s3
    s_lshl_b32 s48, s43, 10
    s_lshl_b32 s3, s46, 6
    s_add_u32 s48, s48, s3
    s_mov_b32 s26, 3670016
    s_mov_b32 s27, 0x20000
    s_mov_b32 s10, 7168
    s_mov_b32 s11, 0x20000
    v_lshlrev_b32 v4, 4, v0
    v_mov_b32 v9, 0
    v_mov_b32 v12, -1
    v_mov_b32 v13, -1
    v_mov_b32 v14, -1
    v_mov_b32 v15, -1
    s_lshl_b32 s49, s43, 5
    s_add_u32 s49, s49, s41
    s_lshl_b32 s49, s49, 10
    s_add_u32 s49, s49, 0x120000
    s_add_u32 s50, s49, 0x40000
    s_mov_b32 s3, 0x80000
    s_cmp_eq_u32 s41, 0
    s_cselect_b32 s51, s3, 0x7ff00000
    v_mov_b32 v17, s43
    v_cmp_lt_u32 vcc, 59, v0
    v_lshlrev_b32 v16, 11, v7
    s_nop 0
    v_cndmask_b32 v17, v45, v17, vcc
    v_lshl_add_u32 v16, v17, 8, v16
    s_mov_b32 s22, 0x300000
    s_mov_b32 s23, 0x20000
    s_mov_b32 s4, 0x20000
    s_movk_i32 s5, 0x400
    s_movk_i32 s6, 28672
    s_movk_i32 s7, 4096
    s_mov_b32 m0, 0
    s_bfe_u32 s45, s41, 0x10001
    s_waitcnt lgkmcnt(0)
    s_cselect_b64 s[24:25], s[32:33], s[62:63]
    s_cselect_b64 s[8:9], s[66:67], s[56:57]
L_wqa:
    buffer_load_dwordx4 v8, s[24:27], s48 offen nt lds
    s_add_u32 m0, m0, s5
    s_add_u32 s48, s48, s4
    s_cmp_lg_u32 m0, s7
    s_cbranch_scc1 L_wqa
    s_mov_b32 m0, 65600
    s_mov_b32 s3, 0
    buffer_load_dwordx4 v4, s[8:11], s3 offen offset:0 lds
    buffer_load_dwordx4 v4, s[8:11], s3 offen offset:1024 lds
    buffer_load_dwordx4 v4, s[8:11], s3 offen offset:2048 lds
    buffer_load_dwordx4 v4, s[8:11], s3 offen offset:3072 lds
    s_mov_b32 m0, 69696
    s_mov_b32 s3, 4096
    buffer_load_dwordx4 v4, s[8:11], s3 offen offset:0 lds
    buffer_load_dwordx4 v4, s[8:11], s3 offen offset:1024 lds
    buffer_load_dwordx4 v4, s[8:11], s3 offen offset:2048 lds
    s_mov_b64 s[20:21], s[12:13]
    buffer_load_dwordx2 v[10:11], v9, s[20:23], 0 offen sc1
    buffer_store_dwordx4 v[12:15], v4, s[20:23], s49 offen sc1
    buffer_store_dwordx4 v[12:15], v4, s[20:23], s50 offen sc1
    buffer_store_dword v9, v16, s[20:23], s51 offen sc1
    s_mov_b32 m0, 4096
    s_nop 0
L_wqb:
    buffer_load_dwordx4 v8, s[24:27], s48 offen nt lds
    s_add_u32 m0, m0, s5
    s_add_u32 s48, s48, s4
    s_cmp_lg_u32 m0, s6
    s_cbranch_scc1 L_wqb
    s_barrier
    s_mov_b64 s[28:29], s[34:35]
    s_mov_b64 s[16:17], s[36:37]
    s_mov_b32 s18, 14336
    s_mov_b32 s19, 0x20000
    v_and_b32 v2, 15, v0
    v_lshrrev_b32 v3, 4, v0
    v_and_b32 v5, 7, v0
    v_mov_b32 v27, 63488
    v_mul_u32_u24 v6, 896, v5
    v_lshl_add_u32 v6, v3, 4, v6
    v_add_u32 v6, 65600, v6
    v_lshrrev_b32 v44, 2, v2
    v_lshl_add_u32 v44, v3, 3, v44
    v_lshlrev_b32 v44, 6, v44
    v_lshl_add_u32 v44, v45, 3, v44
    v_lshrrev_b32 v45, 3, v2
    v_lshl_add_u32 v46, v45, 2, v3
    v_lshlrev_b32 v46, 4, v46
    v_lshl_add_u32 v46, v5, 11, v46
    s_lshl_b32 s53, s45, 3
    s_add_u32 s53, s53, s43
    s_lshl_b32 s53, s53, 14
    s_lshl_b32 s3, s46, 7
    s_add_u32 s53, s53, s3
    s_add_u32 s53, s53, 0x10000
    s_lshl_b32 s52, s43, 3
    s_add_u32 s52, s52, s42
    s_lshl_b32 s52, s52, 11
    s_add_u32 s52, s52, 0x10000
    v_cmp_lt_u32 vcc, 7, v2
    s_mov_b32 s63, 0x40000
    ds_write_b32 v27, v9 offset:0
    ds_write_b32 v27, v9 offset:4
    ds_write_b32 v27, v9 offset:8
    ds_write_b32 v27, v9 offset:12
    ds_write_b32 v27, v9 offset:16
    ds_write_b32 v27, v9 offset:24
    s_mov_b32 s51, s53
    s_waitcnt vmcnt(24)
    ds_read_b128 v[112:115], v6 offset:0
    ds_read_b128 v[116:119], v6 offset:64
    ds_read_b64_tr_b16 v[64:65], v44 offset:0
    ds_read_b64_tr_b16 v[66:67], v44 offset:256
    ds_read_b64_tr_b16 v[68:69], v44 offset:32
    ds_read_b64_tr_b16 v[70:71], v44 offset:288
    ds_read_b64_tr_b16 v[72:73], v44 offset:2048
    ds_read_b64_tr_b16 v[74:75], v44 offset:2304
    ds_read_b64_tr_b16 v[76:77], v44 offset:2080
    ds_read_b64_tr_b16 v[78:79], v44 offset:2336
    v_add_u32 v10, 0x9e3779b9, v10
    v_add_u32 v11, 0x85ebca6b, v11
    v_mov_b32 v97, v10
    v_mov_b32 v99, v11
    v_mov_b32 v101, v10
    v_mov_b32 v103, v11
    s_waitcnt lgkmcnt(0)
    v_mfma_f32_16x16x32_bf16 v[48:51], v[64:67], v[112:115], 0
    v_mfma_f32_16x16x32_bf16 v[52:55], v[68:71], v[112:115], 0
    v_mfma_f32_16x16x32_bf16 v[56:59], v[72:75], v[116:119], 0
    v_mfma_f32_16x16x32_bf16 v[60:63], v[76:79], v[116:119], 0
    s_waitcnt vmcnt(20)
    ds_read_b128 v[120:123], v6 offset:128
    ds_read_b128 v[124:127], v6 offset:192
    ds_read_b64_tr_b16 v[80:81], v44 offset:4096
    ds_read_b64_tr_b16 v[82:83], v44 offset:4352
    ds_read_b64_tr_b16 v[84:85], v44 offset:4128
    ds_read_b64_tr_b16 v[86:87], v44 offset:4384
    ds_read_b64_tr_b16 v[88:89], v44 offset:6144
    ds_read_b64_tr_b16 v[90:91], v44 offset:6400
    ds_read_b64_tr_b16 v[92:93], v44 offset:6176
    ds_read_b64_tr_b16 v[94:95], v44 offset:6432
    s_waitcnt lgkmcnt(0)
    v_mfma_f32_16x16x32_bf16 v[48:51], v[80:83], v[120:123], v[48:51]
    v_mfma_f32_16x16x32_bf16 v[52:55], v[84:87], v[120:123], v[52:55]
    v_mfma_f32_16x16x32_bf16 v[56:59], v[88:91], v[124:127], v[56:59]
    v_mfma_f32_16x16x32_bf16 v[60:63], v[92:95], v[124:127], v[60:63]
    s_waitcnt vmcnt(16)
    ds_read_b128 v[128:131], v6 offset:256
    ds_read_b128 v[132:135], v6 offset:320
    ds_read_b64_tr_b16 v[64:65], v44 offset:8192
    ds_read_b64_tr_b16 v[66:67], v44 offset:8448
    ds_read_b64_tr_b16 v[68:69], v44 offset:8224
    ds_read_b64_tr_b16 v[70:71], v44 offset:8480
    ds_read_b64_tr_b16 v[72:73], v44 offset:10240
    ds_read_b64_tr_b16 v[74:75], v44 offset:10496
    ds_read_b64_tr_b16 v[76:77], v44 offset:10272
    ds_read_b64_tr_b16 v[78:79], v44 offset:10528
    s_waitcnt lgkmcnt(0)
    v_mfma_f32_16x16x32_bf16 v[48:51], v[64:67], v[128:131], v[48:51]
    v_mfma_f32_16x16x32_bf16 v[52:55], v[68:71], v[128:131], v[52:55]
    v_mfma_f32_16x16x32_bf16 v[56:59], v[72:75], v[132:135], v[56:59]
    v_mfma_f32_16x16x32_bf16 v[60:63], v[76:79], v[132:135], v[60:63]
    s_waitcnt vmcnt(12)
    ds_read_b128 v[136:139], v6 offset:384
    ds_read_b128 v[140:143], v6 offset:448
    ds_read_b64_tr_b16 v[80:81], v44 offset:12288
    ds_read_b64_tr_b16 v[82:83], v44 offset:12544
    ds_read_b64_tr_b16 v[84:85], v44 offset:12320
    ds_read_b64_tr_b16 v[86:87], v44 offset:12576
    ds_read_b64_tr_b16 v[88:89], v44 offset:14336
    ds_read_b64_tr_b16 v[90:91], v44 offset:14592
    ds_read_b64_tr_b16 v[92:93], v44 offset:14368
    ds_read_b64_tr_b16 v[94:95], v44 offset:14624
    s_waitcnt lgkmcnt(0)
    v_mfma_f32_16x16x32_bf16 v[48:51], v[80:83], v[136:139], v[48:51]
    v_mfma_f32_16x16x32_bf16 v[52:55], v[84:87], v[136:139], v[52:55]
    v_mfma_f32_16x16x32_bf16 v[56:59], v[88:91], v[140:143], v[56:59]
    v_mfma_f32_16x16x32_bf16 v[60:63], v[92:95], v[140:143], v[60:63]
    s_waitcnt vmcnt(8)
    ds_read_b128 v[144:147], v6 offset:512
    ds_read_b128 v[148:151], v6 offset:576
    ds_read_b64_tr_b16 v[64:65], v44 offset:16384
    ds_read_b64_tr_b16 v[66:67], v44 offset:16640
    ds_read_b64_tr_b16 v[68:69], v44 offset:16416
    ds_read_b64_tr_b16 v[70:71], v44 offset:16672
    ds_read_b64_tr_b16 v[72:73], v44 offset:18432
    ds_read_b64_tr_b16 v[74:75], v44 offset:18688
    ds_read_b64_tr_b16 v[76:77], v44 offset:18464
    ds_read_b64_tr_b16 v[78:79], v44 offset:18720
    s_waitcnt lgkmcnt(0)
    v_mfma_f32_16x16x32_bf16 v[48:51], v[64:67], v[144:147], v[48:51]
    v_mfma_f32_16x16x32_bf16 v[52:55], v[68:71], v[144:147], v[52:55]
    v_mfma_f32_16x16x32_bf16 v[56:59], v[72:75], v[148:151], v[56:59]
    v_mfma_f32_16x16x32_bf16 v[60:63], v[76:79], v[148:151], v[60:63]
    s_waitcnt vmcnt(4)
    ds_read_b128 v[152:155], v6 offset:640
    ds_read_b128 v[156:159], v6 offset:704
    ds_read_b64_tr_b16 v[80:81], v44 offset:20480
    ds_read_b64_tr_b16 v[82:83], v44 offset:20736
    ds_read_b64_tr_b16 v[84:85], v44 offset:20512
    ds_read_b64_tr_b16 v[86:87], v44 offset:20768
    ds_read_b64_tr_b16 v[88:89], v44 offset:22528
    ds_read_b64_tr_b16 v[90:91], v44 offset:22784
    ds_read_b64_tr_b16 v[92:93], v44 offset:22560
    ds_read_b64_tr_b16 v[94:95], v44 offset:22816
    s_waitcnt lgkmcnt(0)
    v_mfma_f32_16x16x32_bf16 v[48:51], v[80:83], v[152:155], v[48:51]
    v_mfma_f32_16x16x32_bf16 v[52:55], v[84:87], v[152:155], v[52:55]
    v_mfma_f32_16x16x32_bf16 v[56:59], v[88:91], v[156:159], v[56:59]
    v_mfma_f32_16x16x32_bf16 v[60:63], v[92:95], v[156:159], v[60:63]
    s_waitcnt vmcnt(0)
    ds_read_b128 v[160:163], v6 offset:768
    ds_read_b128 v[164:167], v6 offset:832
    ds_read_b64_tr_b16 v[64:65], v44 offset:24576
    ds_read_b64_tr_b16 v[66:67], v44 offset:24832
    ds_read_b64_tr_b16 v[68:69], v44 offset:24608
    ds_read_b64_tr_b16 v[70:71], v44 offset:24864
    ds_read_b64_tr_b16 v[72:73], v44 offset:26624
    ds_read_b64_tr_b16 v[74:75], v44 offset:26880
    ds_read_b64_tr_b16 v[76:77], v44 offset:26656
    ds_read_b64_tr_b16 v[78:79], v44 offset:26912
    s_waitcnt lgkmcnt(0)
    v_mfma_f32_16x16x32_bf16 v[48:51], v[64:67], v[160:163], v[48:51]
    v_mfma_f32_16x16x32_bf16 v[52:55], v[68:71], v[160:163], v[52:55]
    v_mfma_f32_16x16x32_bf16 v[56:59], v[72:75], v[164:167], v[56:59]
    v_mfma_f32_16x16x32_bf16 v[60:63], v[76:79], v[164:167], v[60:63]
    s_nop 7
    v_add_f32 v48, v48, v56
    v_add_f32 v49, v49, v57
    v_add_f32 v50, v50, v58
    v_add_f32 v51, v51, v59
    v_add_f32 v52, v52, v60
    v_add_f32 v53, v53, v61
    v_add_f32 v54, v54, v62
    v_add_f32 v55, v55, v63
    v_cndmask_b32 v48, v48, v52, vcc
    v_cndmask_b32 v49, v49, v53, vcc
    v_cndmask_b32 v50, v50, v54, vcc
    v_cndmask_b32 v51, v51, v55, vcc
    v_cvt_pk_bf16_f32 v96, v48, v49
    v_cvt_pk_bf16_f32 v98, v50, v51
    buffer_store_dwordx4 v[96:99], v46, s[20:23], s51 offen sc1
    v_lshlrev_b32 v47, 3, v0
    v_add_u32 v47, 61440, v47
    v_add_u32 v25, 81984, v4
    v_bfe_u32 v17, v0, 3, 1
    v_lshl_add_u32 v18, v3, 3, v5
    v_lshlrev_b32 v18, 4, v18
    v_lshl_add_u32 v18, v17, 9, v18
    v_lshlrev_b32 v16, 7, v5
    v_lshl_add_u32 v16, v17, 6, v16
    v_lshl_add_u32 v16, v3, 4, v16
    v_add_u32 v16, 65600, v16
    v_lshlrev_b32 v19, 4, v17
    v_lshl_add_u32 v21, v3, 8, v19
    s_lshl_b32 s57, s40, 8
    s_add_u32 s57, s57, 0x60000
    s_andn2_b32 s56, s57, 0x300
    s_mul_i32 s54, s41, 37
    s_lshr_b32 s54, s54, 8
    s_mul_i32 s3, s54, 7
    s_sub_u32 s55, s41, s3
    v_lshrrev_b32 v28, 3, v0
    v_mul_u32_u24 v28, 896, v28
    v_and_b32 v29, 7, v0
    v_lshl_add_u32 v168, v29, 4, v28
    v_xor_b32 v169, 32, v168
    v_xor_b32 v170, 64, v168
    v_xor_b32 v171, 96, v168
    s_lshl_b32 s48, s43, 3
    s_and_b32 s3, s54, 2
    s_lshl_b32 s3, s3, 1
    s_add_u32 s48, s48, s3
    s_and_b32 s3, s54, 1
    s_add_u32 s48, s48, s3
    s_mul_i32 s48, s48, 64*896
    s_lshl_b32 s3, s55, 7
    s_add_u32 s48, s48, s3
    s_cmp_ge_u32 s41, 28
    s_cselect_b32 s30, 0, 3670016
    s_mov_b32 s31, 0x20000
    v_lshrrev_b32 v22, 1, v2
    v_and_b32 v23, 1, v2
    v_lshl_add_u32 v20, v22, 2, v23
    v_lshlrev_b32 v20, 10, v20
    v_lshl_add_u32 v20, v3, 4, v20
    s_lshl_b32 s58, s43, 15
    s_lshl_b32 s3, s54, 8
    s_add_u32 s58, s58, s3
    s_add_u32 s58, s58, 0x160000
    v_lshl_add_u32 v26, v23, 2, v3
    v_lshlrev_b32 v26, 4, v26
    v_lshl_add_u32 v22, v22, 13, v26
    v_cmp_eq_u32 s[36:37], 1, v23
    s_lshl_b32 s59, s55, 16
    s_lshl_b32 s3, s43, 2
    s_add_u32 s3, s3, s54
    s_lshl_b32 s3, s3, 7
    s_add_u32 s59, s59, s3
    s_add_u32 s59, s59, 0x270000
    s_add_u32 s65, s59, 0x1000
    v_lshrrev_b32 v45, 2, v2
    v_lshl_add_u32 v44, v45, 3, v3
    v_lshlrev_b32 v44, 7, v44
    v_lshl_add_u32 v44, v45, 5, v44
    v_and_b32 v45, 3, v0
    v_lshl_add_u32 v164, v45, 3, v44
    v_xor_b32 v165, 32, v164
    v_xor_b32 v166, 64, v164
    v_xor_b32 v167, 96, v164
    ds_write_b64 v27, v[10:11] offset:32
    s_mul_i32 s60, s43, 28
    s_add_u32 s60, s60, s41
    s_and_b32 s4, s60, 1
    s_lshr_b32 s5, s60, 1
    s_mul_i32 s61, s4, 112
    s_add_u32 s61, s61, s5
    s_lshl_b32 s61, s61, 12
    s_add_u32 s61, s61, 0x200000
    s_bfe_u32 s3, s5, 0x30001
    s_mul_i32 s62, s3, 1792
    s_mul_i32 s3, s4, 896
    s_add_u32 s62, s62, s3
    s_lshr_b32 s3, s5, 4
    s_lshl_b32 s3, s3, 7
    s_add_u32 s62, s62, s3
    s_and_b32 s3, s5, 1
    s_lshl_b32 s3, s3, 6
    s_add_u32 s62, s62, s3
    v_lshrrev_b32 v156, 1, v3
    v_and_b32 v157, 1, v3
    v_lshl_add_u32 v156, v157, 1, v156
    v_lshl_add_u32 v156, v5, 2, v156
    v_lshlrev_b32 v156, 1, v156
    v_mov_b32 v158, 0x3f80
    v_mov_b32 v159, 0x3f800000
    s_mov_b32 s34, 0x00ff00ff
    s_mov_b32 s35, 0x00ff00ff
    s_mov_b32 s64, 0x3db8aa3b
    v_lshlrev_b32 v26, 2, v0
    v_add_u32 v26, 63552, v26
    s_mov_b32 s47, 0x80000
    s_mul_i32 s67, s42, 3
    s_add_u32 s67, s67, s40
    s_lshl_b32 s67, s67, 8
    s_lshl_b32 s66, s42, 8
    s_mov_b32 s38, 0
    s_waitcnt vmcnt(0)
L_qpoll:
    buffer_load_dwordx4 v[64:67], v4, s[20:23], s52 offen offset:0 sc1
    buffer_load_dwordx4 v[68:71], v4, s[20:23], s52 offen offset:1024 sc1
    s_mov_b64 exec, -1
    s_waitcnt vmcnt(0)
    v_xor_b32 v30, v65, v10
    v_bitop3_b32 v30, v67, v11, v30 bitop3:0xbe
    v_bitop3_b32 v30, v69, v10, v30 bitop3:0xbe
    v_bitop3_b32 v30, v71, v11, v30 bitop3:0xbe
    v_cmp_ne_u32 vcc, 0, v30
    s_cbranch_vccz L_qdone
    s_mov_b64 exec, vcc
    s_sleep 4
    s_sub_u32 s63, s63, 1
    s_cmp_lg_u32 s63, 0
    s_cbranch_scc1 L_qpoll
    s_mov_b32 s63, 1
    s_mov_b64 exec, -1
L_qdone:
    ds_write2_b32 v47, v64, v66 offset0:0 offset1:1
    ds_write2_b32 v47, v68, v70 offset0:128 offset1:129
    s_waitcnt lgkmcnt(0)
    s_cmp_lg_u32 s38, 0
    s_cbranch_scc1 L_qboth
    s_barrier
    s_mov_b32 s38, 1
    s_add_u32 s52, s52, 0x20000
    v_add_u32 v47, 1024, v47
L_wb:
    s_sleep 4
    ds_read_b32 v30, v27 offset:12
    s_waitcnt lgkmcnt(0)
    v_readfirstlane_b32 s3, v30
    s_nop 3
    s_cmp_lt_u32 s3, 1
    s_cbranch_scc1 L_wb
    s_branch L_qpoll
L_qboth:
    v_mov_b32 v45, 1
    ds_write_b32 v27, v45 offset:8
    s_mov_b32 s38, 0
    s_mov_b32 s39, 1
    s_mov_b32 s14, 4
    s_mov_b32 s15, 4
L_phase:
L_wk:
    s_sleep 4
    ds_read_b32 v30, v27 offset:0
    ds_read_b32 v31, v27 offset:12
    s_waitcnt lgkmcnt(0)
    v_readfirstlane_b32 s3, v30
    v_readfirstlane_b32 s4, v31
    s_nop 3
    s_cmp_lt_u32 s4, s14
    s_cbranch_scc1 L_wkn
    s_and_b32 s5, s67, 0x300
    s_add_u32 s5, s5, s47
    s_add_u32 s67, s67, s66
    s_mov_b32 s4, 1
    s_atomic_add s4, s[20:21], s5 glc
    s_add_u32 s14, s14, 4
    s_add_u32 s47, s47, 0x800
    s_waitcnt lgkmcnt(0)
    s_cmp_ge_u32 s4, 46
    s_cselect_b32 s4, 1, 0
    v_mov_b32 v31, s4
    ds_write_b32 v27, v31 offset:24
L_wkn:
    s_cmp_lt_u32 s3, s15
    s_cbranch_scc1 L_wk
    ds_read_b32 v148, v26 offset:0
    ds_read_b32 v150, v26 offset:256
    ds_read_b32 v152, v26 offset:512
    ds_read_b32 v154, v26 offset:768
    ds_read_b128 v[48:51], v16 offset:0
    ds_read_b128 v[52:55], v16 offset:1024
    ds_read_b128 v[56:59], v16 offset:2048
    ds_read_b128 v[60:63], v16 offset:3072
    ds_read_b128 v[64:67], v16 offset:4096
    ds_read_b128 v[68:71], v16 offset:5120
    ds_read_b128 v[72:75], v16 offset:6144
    ds_read_b128 v[76:79], v16 offset:7168
    s_waitcnt lgkmcnt(0)
    v_max3_f32 v32, v148, v150, v152
    v_max_f32 v32, v32, v154
    v_fma_f32 v48, v48, s64, -v32
    v_fma_f32 v49, v49, s64, -v32
    v_fma_f32 v50, v50, s64, -v32
    v_fma_f32 v51, v51, s64, -v32
    v_fma_f32 v52, v52, s64, -v32
    v_fma_f32 v53, v53, s64, -v32
    v_fma_f32 v54, v54, s64, -v32
    v_fma_f32 v55, v55, s64, -v32
    v_fma_f32 v56, v56, s64, -v32
    v_fma_f32 v57, v57, s64, -v32
    v_fma_f32 v58, v58, s64, -v32
    v_fma_f32 v59, v59, s64, -v32
    v_fma_f32 v60, v60, s64, -v32
    v_fma_f32 v61, v61, s64, -v32
    v_fma_f32 v62, v62, s64, -v32
    v_fma_f32 v63, v63, s64, -v32
    v_fma_f32 v64, v64, s64, -v32
    v_fma_f32 v65, v65, s64, -v32
    v_fma_f32 v66, v66, s64, -v32
    v_fma_f32 v67, v67, s64, -v32
    v_fma_f32 v68, v68, s64, -v32
    v_fma_f32 v69, v69, s64, -v32
    v_fma_f32 v70, v70, s64, -v32
    v_fma_f32 v71, v71, s64, -v32
    v_fma_f32 v72, v72, s64, -v32
    v_fma_f32 v73, v73, s64, -v32
    v_fma_f32 v74, v74, s64, -v32
    v_fma_f32 v75, v75, s64, -v32
    v_fma_f32 v76, v76, s64, -v32
    v_fma_f32 v77, v77, s64, -v32
    v_fma_f32 v78, v78, s64, -v32
    v_fma_f32 v79, v79, s64, -v32
    v_exp_f32 v48, v48
    v_exp_f32 v49, v49
    v_exp_f32 v50, v50
    v_exp_f32 v51, v51
    v_exp_f32 v52, v52
    v_exp_f32 v53, v53
    v_exp_f32 v54, v54
    v_exp_f32 v55, v55
    v_exp_f32 v56, v56
    v_exp_f32 v57, v57
    v_exp_f32 v58, v58
    v_exp_f32 v59, v59
    v_exp_f32 v60, v60
    v_exp_f32 v61, v61
    v_exp_f32 v62, v62
    v_exp_f32 v63, v63
    v_exp_f32 v64, v64
    v_exp_f32 v65, v65
    v_exp_f32 v66, v66
    v_exp_f32 v67, v67
    v_exp_f32 v68, v68
    v_exp_f32 v69, v69
    v_exp_f32 v70, v70
    v_exp_f32 v71, v71
    v_exp_f32 v72, v72
    v_exp_f32 v73, v73
    v_exp_f32 v74, v74
    v_exp_f32 v75, v75
    v_exp_f32 v76, v76
    v_exp_f32 v77, v77
    v_exp_f32 v78, v78
    v_exp_f32 v79, v79
    v_add_f32 v48, v48, v64
    v_add_f32 v49, v49, v65
    v_add_f32 v50, v50, v66
    v_add_f32 v51, v51, v67
    v_add_f32 v52, v52, v68
    v_add_f32 v53, v53, v69
    v_add_f32 v54, v54, v70
    v_add_f32 v55, v55, v71
    v_add_f32 v56, v56, v72
    v_add_f32 v57, v57, v73
    v_add_f32 v58, v58, v74
    v_add_f32 v59, v59, v75
    v_add_f32 v60, v60, v76
    v_add_f32 v61, v61, v77
    v_add_f32 v62, v62, v78
    v_add_f32 v63, v63, v79
    v_add_f32 v48, v48, v56
    v_add_f32 v49, v49, v57
    v_add_f32 v50, v50, v58
    v_add_f32 v51, v51, v59
    v_add_f32 v52, v52, v60
    v_add_f32 v53, v53, v61
    v_add_f32 v54, v54, v62
    v_add_f32 v55, v55, v63
    v_add_f32 v48, v48, v52
    v_add_f32 v49, v49, v53
    v_add_f32 v50, v50, v54
    v_add_f32 v51, v51, v55
    v_add_f32 v48, v48, v50
    v_add_f32 v49, v49, v51
    v_add_f32 v48, v48, v49
    s_nop 1
    v_add_f32_dpp v48, v48, v48 row_half_mirror row_mask:0xf bank_mask:0xf
    s_nop 1
    v_add_f32_dpp v48, v48, v48 quad_perm:[1,0,3,2] row_mask:0xf bank_mask:0xf
    s_nop 1
    v_add_f32_dpp v48, v48, v48 quad_perm:[2,3,0,1] row_mask:0xf bank_mask:0xf
    s_nop 1
    v_mov_b32 v30, v48
    s_nop 1
    v_permlane16_swap_b32 v30, v48
    s_nop 1
    v_add_f32 v48, v48, v30
    v_mov_b32 v30, v48
    s_nop 1
    v_permlane32_swap_b32 v30, v48
    s_nop 1
    v_add_f32 v48, v48, v30
    v_mov_b32 v33, v10
    v_mov_b32 v34, v48
    v_mov_b32 v35, v11
    s_mov_b64 exec, 0x101
    buffer_store_dwordx4 v[32:35], v19, s[20:23], s57 offen sc1
    s_mov_b64 exec, -1
    s_cmp_lg_u32 s38, 0
    s_cbranch_scc1 L_wm
L_wf:
    s_sleep 4
    ds_read_b32 v30, v27 offset:4
    ds_read_b32 v31, v27 offset:12
    s_waitcnt lgkmcnt(0)
    v_readfirstlane_b32 s3, v30
    v_readfirstlane_b32 s4, v31
    s_nop 3
    s_cmp_lt_u32 s4, s14
    s_cbranch_scc1 L_wfn
    s_and_b32 s5, s67, 0x300
    s_add_u32 s5, s5, s47
    s_add_u32 s67, s67, s66
    s_mov_b32 s4, 1
    s_atomic_add s4, s[20:21], s5 glc
    s_add_u32 s14, s14, 4
    s_add_u32 s47, s47, 0x800
    s_waitcnt lgkmcnt(0)
    s_cmp_ge_u32 s4, 46
    s_cselect_b32 s4, 1, 0
    v_mov_b32 v31, s4
    ds_write_b32 v27, v31 offset:24
L_wfn:
    s_cmp_lt_u32 s3, 4
    s_cbranch_scc1 L_wf
    s_branch L_pollm
L_wm:
    s_sleep 4
    ds_read_b32 v30, v27 offset:12
    ds_read_b32 v31, v27 offset:12
    s_waitcnt lgkmcnt(0)
    v_readfirstlane_b32 s3, v30
    v_readfirstlane_b32 s4, v31
    s_nop 3
    s_cmp_lt_u32 s4, s14
    s_cbranch_scc1 L_wmn
    s_and_b32 s5, s67, 0x300
    s_add_u32 s5, s5, s47
    s_add_u32 s67, s67, s66
    s_mov_b32 s4, 1
    s_atomic_add s4, s[20:21], s5 glc
    s_add_u32 s14, s14, 4
    s_add_u32 s47, s47, 0x800
    s_waitcnt lgkmcnt(0)
    s_cmp_ge_u32 s4, 46
    s_cselect_b32 s4, 1, 0
    v_mov_b32 v31, s4
    ds_write_b32 v27, v31 offset:24
L_wmn:
    s_cmp_lt_u32 s3, 56
    s_cbranch_scc1 L_wm
L_pollm:
    buffer_load_dwordx4 v[36:39], v21, s[20:23], s56 offen sc1
    s_mov_b64 exec, -1
    s_waitcnt vmcnt(0)
    v_xor_b32 v30, v37, v10
    v_bitop3_b32 v30, v39, v11, v30 bitop3:0xbe
    v_cmp_ne_u32 vcc, 0, v30
    s_cbranch_vccz L_donem
    s_mov_b64 exec, vcc
    s_sleep 16
    s_sub_u32 s63, s63, 1
    s_cmp_lg_u32 s63, 0
    s_cbranch_scc1 L_pollm
    s_mov_b32 s63, 1
    s_mov_b64 exec, -1
L_donem:
    v_mov_b32 v28, v36
    v_mov_b32 v30, v28
    s_nop 1
    v_permlane16_swap_b32 v30, v28
    s_nop 1
    v_max_f32 v28, v28, v30
    v_mov_b32 v30, v28
    s_nop 1
    v_permlane32_swap_b32 v30, v28
    s_nop 1
    v_max_f32 v28, v28, v30
    v_sub_f32 v148, v148, v28
    v_sub_f32 v150, v150, v28
    v_sub_f32 v152, v152, v28
    v_sub_f32 v154, v154, v28
    v_exp_f32 v148, v148
    v_exp_f32 v150, v150
    v_exp_f32 v152, v152
    v_exp_f32 v154, v154
    v_sub_f32 v36, v36, v28
    v_exp_f32 v36, v36
    s_nop 0
    v_mul_f32 v36, v36, v38
    v_mov_b32 v30, v36
    s_nop 1
    v_permlane16_swap_b32 v30, v36
    s_nop 1
    v_add_f32 v36, v36, v30
    v_mov_b32 v30, v36
    s_nop 1
    v_permlane32_swap_b32 v30, v36
    s_nop 1
    v_add_f32 v36, v36, v30
    v_rcp_f32 v32, v36
    s_nop 0
    v_mul_f32 v148, v148, v32
    v_mul_f32 v150, v150, v32
    v_mul_f32 v152, v152, v32
    v_mul_f32 v154, v154, v32
    v_add_u32 v16, 8192, v16
    v_add_u32 v26, 1024, v26
    s_add_u32 s56, s56, 0x10000
    s_add_u32 s57, s57, 0x10000
    s_cmp_eq_u32 s38, 0
    s_cbranch_scc1 L_merge
L_wh:
    s_sleep 2
    ds_read_b32 v30, v27 offset:16
    s_waitcnt lgkmcnt(0)
    v_readfirstlane_b32 s3, v30
    s_nop 3
    s_cmp_lt_u32 s3, 28
    s_cbranch_scc1 L_wh
    s_and_b32 s5, s67, 0x300
    s_add_u32 s5, s5, s47
    s_mov_b32 s4, 1
    s_atomic_add s4, s[20:21], s5 glc
    s_waitcnt lgkmcnt(0)
    s_cmp_ge_u32 s4, 36
    s_cselect_b32 s4, 1, 0
    v_mov_b32 v31, s4
    ds_write_b32 v27, v31 offset:24
    s_lshl_b32 s47, s43, 8
    s_add_u32 s47, s47, 0x87800
L_wd:
    s_sleep 1
    ds_read_b32 v30, v27 offset:12
    s_waitcnt lgkmcnt(0)
    v_readfirstlane_b32 s3, v30
    s_nop 3
    s_cmp_lt_u32 s3, 64
    s_cbranch_scc1 L_wd
    s_mov_b32 m0, 45056
    s_nop 0
    buffer_load_dwordx4 v168, s[28:31], s48 offen nt lds
    s_mov_b32 m0, 46080
    s_add_u32 s48, s48, 7168
    buffer_load_dwordx4 v169, s[28:31], s48 offen nt lds
    s_mov_b32 m0, 47104
    s_add_u32 s48, s48, 7168
    buffer_load_dwordx4 v170, s[28:31], s48 offen nt lds
    s_mov_b32 m0, 48128
    s_add_u32 s48, s48, 7168
    buffer_load_dwordx4 v171, s[28:31], s48 offen nt lds
    s_mov_b32 m0, 49152
    s_add_u32 s48, s48, 7168
    buffer_load_dwordx4 v168, s[28:31], s48 offen nt lds
    s_mov_b32 m0, 50176
    s_add_u32 s48, s48, 7168
    buffer_load_dwordx4 v169, s[28:31], s48 offen nt lds
    s_mov_b32 m0, 51200
    s_add_u32 s48, s48, 7168
    buffer_load_dwordx4 v170, s[28:31], s48 offen nt lds
    s_mov_b32 m0, 52224
    s_add_u32 s48, s48, 7168
    buffer_load_dwordx4 v171, s[28:31], s48 offen nt lds
    s_mov_b32 m0, 53248
    s_add_u32 s48, s48, 64512
    buffer_load_dwordx4 v168, s[28:31], s48 offen nt lds
    s_mov_b32 m0, 54272
    s_add_u32 s48, s48, 7168
    buffer_load_dwordx4 v169, s[28:31], s48 offen nt lds
    s_mov_b32 m0, 55296
    s_add_u32 s48, s48, 7168
    buffer_load_dwordx4 v170, s[28:31], s48 offen nt lds
    s_mov_b32 m0, 56320
    s_add_u32 s48, s48, 7168
    buffer_load_dwordx4 v171, s[28:31], s48 offen nt lds
    s_mov_b32 m0, 57344
    s_add_u32 s48, s48, 7168
    buffer_load_dwordx4 v168, s[28:31], s48 offen nt lds
    s_mov_b32 m0, 58368
    s_add_u32 s48, s48, 7168
    buffer_load_dwordx4 v169, s[28:31], s48 offen nt lds
    s_mov_b32 m0, 59392
    s_add_u32 s48, s48, 7168
    buffer_load_dwordx4 v170, s[28:31], s48 offen nt lds
    s_mov_b32 m0, 60416
    s_add_u32 s48, s48, 7168
    buffer_load_dwordx4 v171, s[28:31], s48 offen nt lds
    s_barrier
L_merge:
    ds_read_b128 v[48:51], v25 offset:0
    ds_read_b128 v[52:55], v25 offset:1024
    ds_read_b128 v[56:59], v25 offset:2048
    ds_read_b128 v[60:63], v25 offset:3072
    ds_read_b128 v[64:67], v25 offset:4096
    ds_read_b128 v[68:71], v25 offset:5120
    ds_read_b128 v[72:75], v25 offset:6144
    ds_read_b128 v[76:79], v25 offset:7168
    s_waitcnt lgkmcnt(6)
    v_pk_mul_f32 v[48:49], v[48:49], v[148:149] op_sel_hi:[1,0]
    v_pk_mul_f32 v[50:51], v[50:51], v[148:149] op_sel_hi:[1,0]
    v_pk_mul_f32 v[52:53], v[52:53], v[148:149] op_sel_hi:[1,0]
    v_pk_mul_f32 v[54:55], v[54:55], v[148:149] op_sel_hi:[1,0]
    s_waitcnt lgkmcnt(4)
    v_pk_fma_f32 v[48:49], v[56:57], v[150:151], v[48:49] op_sel_hi:[1,0,1]
    v_pk_fma_f32 v[50:51], v[58:59], v[150:151], v[50:51] op_sel_hi:[1,0,1]
    v_pk_fma_f32 v[52:53], v[60:61], v[150:151], v[52:53] op_sel_hi:[1,0,1]
    v_pk_fma_f32 v[54:55], v[62:63], v[150:151], v[54:55] op_sel_hi:[1,0,1]
    s_waitcnt lgkmcnt(2)
    v_pk_fma_f32 v[48:49], v[64:65], v[152:153], v[48:49] op_sel_hi:[1,0,1]
    v_pk_fma_f32 v[50:51], v[66:67], v[152:153], v[50:51] op_sel_hi:[1,0,1]
    v_pk_fma_f32 v[52:53], v[68:69], v[152:153], v[52:53] op_sel_hi:[1,0,1]
    v_pk_fma_f32 v[54:55], v[70:71], v[152:153], v[54:55] op_sel_hi:[1,0,1]
    s_waitcnt lgkmcnt(0)
    v_pk_fma_f32 v[48:49], v[72:73], v[154:155], v[48:49] op_sel_hi:[1,0,1]
    v_pk_fma_f32 v[50:51], v[74:75], v[154:155], v[50:51] op_sel_hi:[1,0,1]
    v_pk_fma_f32 v[52:53], v[76:77], v[154:155], v[52:53] op_sel_hi:[1,0,1]
    v_pk_fma_f32 v[54:55], v[78:79], v[154:155], v[54:55] op_sel_hi:[1,0,1]
    v_cvt_pk_bf16_f32 v40, v48, v49
    v_cvt_pk_bf16_f32 v41, v50, v51
    v_cvt_pk_bf16_f32 v42, v52, v53
    v_cvt_pk_bf16_f32 v43, v54, v55
    v_min_u32 v40, -2, v40
    v_min_u32 v41, -2, v41
    v_min_u32 v42, -2, v42
    v_min_u32 v43, -2, v43
    buffer_store_dwordx4 v[40:43], v18, s[20:23], s49 offen sc1
    s_cmp_lg_u32 s38, 0
    s_cbranch_scc1 L_pubb
    s_mov_b32 s38, 1
    s_mov_b32 s49, s50
    s_mov_b32 s15, 8
    v_add_u32 v25, 8192, v25
    s_branch L_phase
L_pubb:
    s_mov_b32 s4, 1
    s_atomic_add s4, s[20:21], s47 glc
    s_cmp_ge_u32 s41, 28
    s_cbranch_scc1 L_noep
    s_waitcnt vmcnt(0)
    ds_read_b64_tr_b16 v[192:193], v164 offset:45056
    ds_read_b64_tr_b16 v[194:195], v164 offset:53248
    ds_read_b64_tr_b16 v[196:197], v165 offset:45056
    ds_read_b64_tr_b16 v[198:199], v165 offset:53248
    ds_read_b64_tr_b16 v[200:201], v166 offset:45056
    ds_read_b64_tr_b16 v[202:203], v166 offset:53248
    ds_read_b64_tr_b16 v[204:205], v167 offset:45056
    ds_read_b64_tr_b16 v[206:207], v167 offset:53248
    ds_read_b64_tr_b16 v[208:209], v164 offset:45568
    ds_read_b64_tr_b16 v[210:211], v164 offset:53760
    ds_read_b64_tr_b16 v[212:213], v165 offset:45568
    ds_read_b64_tr_b16 v[214:215], v165 offset:53760
    ds_read_b64_tr_b16 v[216:217], v166 offset:45568
    ds_read_b64_tr_b16 v[218:219], v166 offset:53760
    s_waitcnt lgkmcnt(12)
    ds_read_b64_tr_b16 v[220:221], v167 offset:45568
    ds_read_b64_tr_b16 v[222:223], v167 offset:53760
    s_waitcnt lgkmcnt(7)
    ds_read_b64_tr_b16 v[224:225], v164 offset:49152
    ds_read_b64_tr_b16 v[226:227], v164 offset:57344
    ds_read_b64_tr_b16 v[228:229], v165 offset:49152
    ds_read_b64_tr_b16 v[230:231], v165 offset:57344
    ds_read_b64_tr_b16 v[232:233], v166 offset:49152
    ds_read_b64_tr_b16 v[234:235], v166 offset:57344
    ds_read_b64_tr_b16 v[236:237], v167 offset:49152
    ds_read_b64_tr_b16 v[238:239], v167 offset:57344
    s_waitcnt lgkmcnt(7)
    ds_read_b64_tr_b16 v[240:241], v164 offset:49664
    ds_read_b64_tr_b16 v[242:243], v164 offset:57856
    ds_read_b64_tr_b16 v[244:245], v165 offset:49664
    ds_read_b64_tr_b16 v[246:247], v165 offset:57856
    ds_read_b64_tr_b16 v[248:249], v166 offset:49664
    ds_read_b64_tr_b16 v[250:251], v166 offset:57856
    ds_read_b64_tr_b16 v[252:253], v167 offset:49664
    ds_read_b64_tr_b16 v[254:255], v167 offset:57856
    s_waitcnt lgkmcnt(0)
L_bk:
    s_cmp_ge_u32 s4, 31
    s_cbranch_scc1 L_poll1
    s_sleep 1
    s_add_u32 s4, s4, 1
    s_branch L_bk
L_poll1:
    buffer_load_dwordx4 v[112:115], v20, s[20:23], s58 offen offset:0 sc1
    buffer_load_dwordx4 v[116:119], v20, s[20:23], s58 offen offset:64 sc1
    buffer_load_dwordx4 v[120:123], v20, s[20:23], s58 offen offset:128 sc1
    buffer_load_dwordx4 v[124:127], v20, s[20:23], s58 offen offset:192 sc1
    buffer_load_dwordx4 v[128:131], v20, s[20:23], s58 offen offset:2048 sc1
    buffer_load_dwordx4 v[132:135], v20, s[20:23], s58 offen offset:2112 sc1
    buffer_load_dwordx4 v[136:139], v20, s[20:23], s58 offen offset:2176 sc1
    buffer_load_dwordx4 v[140:143], v20, s[20:23], s58 offen offset:2240 sc1
L_chk1:
    s_mov_b64 exec, -1
    s_waitcnt vmcnt(7)
    v_mfma_f32_16x16x32_bf16 v[80:83], v[192:195], v[112:115], 0
    v_max_u32 v30, v112, v113
    v_mfma_f32_16x16x32_bf16 v[84:87], v[196:199], v[112:115], 0
    v_max3_u32 v30, v30, v114, v115
    v_mfma_f32_16x16x32_bf16 v[88:91], v[200:203], v[112:115], 0
    v_mfma_f32_16x16x32_bf16 v[92:95], v[204:207], v[112:115], 0
    s_waitcnt vmcnt(6)
    v_mfma_f32_16x16x32_bf16 v[80:83], v[208:211], v[116:119], v[80:83]
    v_max3_u32 v30, v30, v116, v117
    v_mfma_f32_16x16x32_bf16 v[84:87], v[212:215], v[116:119], v[84:87]
    v_max3_u32 v30, v30, v118, v119
    v_mfma_f32_16x16x32_bf16 v[88:91], v[216:219], v[116:119], v[88:91]
    v_mfma_f32_16x16x32_bf16 v[92:95], v[220:223], v[116:119], v[92:95]
    s_waitcnt vmcnt(5)
    v_mfma_f32_16x16x32_bf16 v[80:83], v[224:227], v[120:123], v[80:83]
    v_max3_u32 v30, v30, v120, v121
    v_mfma_f32_16x16x32_bf16 v[84:87], v[228:231], v[120:123], v[84:87]
    v_max3_u32 v30, v30, v122, v123
    v_mfma_f32_16x16x32_bf16 v[88:91], v[232:235], v[120:123], v[88:91]
    v_mfma_f32_16x16x32_bf16 v[92:95], v[236:239], v[120:123], v[92:95]
    s_waitcnt vmcnt(4)
    v_mfma_f32_16x16x32_bf16 v[80:83], v[240:243], v[124:127], v[80:83]
    v_max3_u32 v30, v30, v124, v125
    v_mfma_f32_16x16x32_bf16 v[84:87], v[244:247], v[124:127], v[84:87]
    v_max3_u32 v30, v30, v126, v127
    v_mfma_f32_16x16x32_bf16 v[88:91], v[248:251], v[124:127], v[88:91]
    v_mfma_f32_16x16x32_bf16 v[92:95], v[252:255], v[124:127], v[92:95]
    s_waitcnt vmcnt(3)
    v_mfma_f32_16x16x32_bf16 v[80:83], v[192:195], v[128:131], v[80:83]
    v_max3_u32 v30, v30, v128, v129
    v_mfma_f32_16x16x32_bf16 v[84:87], v[196:199], v[128:131], v[84:87]
    v_max3_u32 v30, v30, v130, v131
    v_mfma_f32_16x16x32_bf16 v[88:91], v[200:203], v[128:131], v[88:91]
    v_mfma_f32_16x16x32_bf16 v[92:95], v[204:207], v[128:131], v[92:95]
    s_waitcnt vmcnt(2)
    v_mfma_f32_16x16x32_bf16 v[80:83], v[208:211], v[132:135], v[80:83]
    v_max3_u32 v30, v30, v132, v133
    v_mfma_f32_16x16x32_bf16 v[84:87], v[212:215], v[132:135], v[84:87]
    v_max3_u32 v30, v30, v134, v135
    v_mfma_f32_16x16x32_bf16 v[88:91], v[216:219], v[132:135], v[88:91]
    v_mfma_f32_16x16x32_bf16 v[92:95], v[220:223], v[132:135], v[92:95]
    s_waitcnt vmcnt(1)
    v_mfma_f32_16x16x32_bf16 v[80:83], v[224:227], v[136:139], v[80:83]
    v_max3_u32 v30, v30, v136, v137
    v_mfma_f32_16x16x32_bf16 v[84:87], v[228:231], v[136:139], v[84:87]
    v_max3_u32 v30, v30, v138, v139
    v_mfma_f32_16x16x32_bf16 v[88:91], v[232:235], v[136:139], v[88:91]
    v_mfma_f32_16x16x32_bf16 v[92:95], v[236:239], v[136:139], v[92:95]
    s_waitcnt vmcnt(0)
    v_mfma_f32_16x16x32_bf16 v[80:83], v[240:243], v[140:143], v[80:83]
    v_max3_u32 v30, v30, v140, v141
    v_mfma_f32_16x16x32_bf16 v[84:87], v[244:247], v[140:143], v[84:87]
    v_max3_u32 v30, v30, v142, v143
    v_mfma_f32_16x16x32_bf16 v[88:91], v[248:251], v[140:143], v[88:91]
    v_mfma_f32_16x16x32_bf16 v[92:95], v[252:255], v[140:143], v[92:95]
    v_cmp_eq_u32 vcc, -1, v30
    s_cbranch_vccz L_done1
    s_mov_b64 exec, vcc
    s_sub_u32 s63, s63, 1
    s_cmp_lg_u32 s63, 0
    s_cbranch_scc1 L_poll1
    s_mov_b32 s63, 1
    s_mov_b64 exec, -1
L_done1:
    s_nop 3
    v_cndmask_b32 v144, v84, v80, s[36:37]
    v_cndmask_b32 v145, v85, v81, s[36:37]
    v_cndmask_b32 v146, v86, v82, s[36:37]
    v_cndmask_b32 v147, v87, v83, s[36:37]
    v_cndmask_b32 v80, v80, v84, s[36:37]
    v_cndmask_b32 v81, v81, v85, s[36:37]
    v_cndmask_b32 v82, v82, v86, s[36:37]
    v_cndmask_b32 v83, v83, v87, s[36:37]
    v_add_f32_dpp v80, v144, v80 quad_perm:[1,0,3,2] row_mask:0xf bank_mask:0xf
    v_add_f32_dpp v81, v145, v81 quad_perm:[1,0,3,2] row_mask:0xf bank_mask:0xf
    v_add_f32_dpp v82, v146, v82 quad_perm:[1,0,3,2] row_mask:0xf bank_mask:0xf
    v_add_f32_dpp v83, v147, v83 quad_perm:[1,0,3,2] row_mask:0xf bank_mask:0xf
    v_cvt_pk_bf16_f32 v96, v80, v81
    v_cvt_pk_bf16_f32 v98, v82, v83
    buffer_store_dwordx4 v[96:99], v22, s[20:23], s59 offen sc1
    v_cndmask_b32 v144, v92, v88, s[36:37]
    v_cndmask_b32 v145, v93, v89, s[36:37]
    v_cndmask_b32 v146, v94, v90, s[36:37]
    v_cndmask_b32 v147, v95, v91, s[36:37]
    v_cndmask_b32 v88, v88, v92, s[36:37]
    v_cndmask_b32 v89, v89, v93, s[36:37]
    v_cndmask_b32 v90, v90, v94, s[36:37]
    v_cndmask_b32 v91, v91, v95, s[36:37]
    v_add_f32_dpp v88, v144, v88 quad_perm:[1,0,3,2] row_mask:0xf bank_mask:0xf
    v_add_f32_dpp v89, v145, v89 quad_perm:[1,0,3,2] row_mask:0xf bank_mask:0xf
    v_add_f32_dpp v90, v146, v90 quad_perm:[1,0,3,2] row_mask:0xf bank_mask:0xf
    v_add_f32_dpp v91, v147, v91 quad_perm:[1,0,3,2] row_mask:0xf bank_mask:0xf
    v_cvt_pk_bf16_f32 v100, v88, v89
    v_cvt_pk_bf16_f32 v102, v90, v91
    buffer_store_dwordx4 v[100:103], v22, s[20:23], s65 offen sc1
    s_cmp_eq_u32 s39, 0
    s_cbranch_scc1 L_end
    s_waitcnt vmcnt(0)
L_poll2:
    buffer_load_dwordx4 v[112:115], v4, s[20:23], s61 offen offset:0 sc1
    buffer_load_dwordx4 v[116:119], v4, s[20:23], s61 offen offset:1024 sc1
    buffer_load_dwordx4 v[120:123], v4, s[20:23], s61 offen offset:2048 sc1
    buffer_load_dwordx4 v[124:127], v4, s[20:23], s61 offen offset:3072 sc1
    s_mov_b64 exec, -1
    s_waitcnt vmcnt(3)
    v_dot2_f32_bf16 v80, v112, v158, 0
    v_dot2_f32_bf16 v81, v112, v159, 0
    v_dot2_f32_bf16 v82, v114, v158, 0
    v_dot2_f32_bf16 v83, v114, v159, 0
    v_xor_b32 v30, v113, v10
    v_bitop3_b32 v30, v115, v11, v30 bitop3:0xbe
    s_waitcnt vmcnt(2)
    v_dot2_f32_bf16 v80, v116, v158, v80
    v_dot2_f32_bf16 v81, v116, v159, v81
    v_dot2_f32_bf16 v82, v118, v158, v82
    v_dot2_f32_bf16 v83, v118, v159, v83
    v_bitop3_b32 v30, v117, v10, v30 bitop3:0xbe
    v_bitop3_b32 v30, v119, v11, v30 bitop3:0xbe
    s_waitcnt vmcnt(1)
    v_dot2_f32_bf16 v80, v120, v158, v80
    v_dot2_f32_bf16 v81, v120, v159, v81
    v_dot2_f32_bf16 v82, v122, v158, v82
    v_dot2_f32_bf16 v83, v122, v159, v83
    v_bitop3_b32 v30, v121, v10, v30 bitop3:0xbe
    v_bitop3_b32 v30, v123, v11, v30 bitop3:0xbe
    s_waitcnt vmcnt(0)
    v_dot2_f32_bf16 v80, v124, v158, v80
    v_dot2_f32_bf16 v81, v124, v159, v81
    v_dot2_f32_bf16 v82, v126, v158, v82
    v_dot2_f32_bf16 v83, v126, v159, v83
    v_bitop3_b32 v30, v125, v10, v30 bitop3:0xbe
    v_bitop3_b32 v30, v127, v11, v30 bitop3:0xbe
    v_cmp_ne_u32 vcc, 0, v30
    s_cbranch_vccz L_done2
    s_mov_b64 exec, vcc
    s_sub_u32 s63, s63, 1
    s_cmp_lg_u32 s63, 0
    s_cbranch_scc1 L_poll2
    s_mov_b32 s63, 1
    s_mov_b64 exec, -1
L_done2:
    v_permlane32_swap_b32 v80, v81
    v_permlane32_swap_b32 v82, v83
    s_nop 0
    v_add_f32 v80, v80, v81
    v_add_f32 v82, v82, v83
    s_nop 1
    v_permlane16_swap_b32 v80, v82
    s_nop 1
    v_add_f32 v80, v80, v82
    s_nop 1
    v_add_f32_dpp v80, v80, v80 row_ror:8 row_mask:0xf bank_mask:0xf
    v_cvt_pk_bf16_f32 v30, v80, v80
    s_mov_b64 exec, s[34:35]
    buffer_store_short v30, v156, s[16:19], s62 offen
    s_cmp_lg_u32 s60, 1
    s_cbranch_scc1 L_noep
    s_mov_b64 exec, 1
    buffer_store_dwordx2 v[10:11], v9, s[20:23], 0 offen sc1
L_noep:
L_end:
    s_endpgm
.p2align 6
L_stream:
    s_sub_u32 s44, s44, 1
    v_and_b32 v4, 15, v0
    v_lshrrev_b32 v5, 4, v0
    v_and_b32 v6, 1, v5
    v_lshlrev_b32 v6, 13, v6
    v_lshl_add_u32 v68, v4, 4, v6
    v_lshrrev_b32 v6, 1, v5
    v_lshl_add_u32 v68, v6, 9, v68
    v_add_u32 v69, 0x20000, v68
    v_add_u32 v70, 0x10000, v68
    v_add_u32 v71, 0x30000, v68
    s_lshr_b32 s6, s40, 2
    s_lshl_b32 s6, s6, 21
    s_lshl_b32 s7, s40, 3
    s_lshr_b32 s3, s40, 4
    s_add_u32 s7, s7, s3
    s_mov_b32 s16, 0
    s_bitcmp1_b32 s44, 0
    s_cselect_b32 s3, 0x8000, 0
    s_xor_b32 s16, s16, s3
    s_bitcmp1_b32 s44, 1
    s_cselect_b32 s3, 0x1000, 0
    s_xor_b32 s16, s16, s3
    s_bitcmp1_b32 s40, 0
    s_cselect_b32 s3, 0x9800, 0
    s_xor_b32 s16, s16, s3
    s_bitcmp1_b32 s40, 1
    s_cselect_b32 s3, 0x40000, 0
    s_xor_b32 s16, s16, s3
    s_bitcmp1_b32 s40, 2
    s_cselect_b32 s3, 0x41000, 0
    s_xor_b32 s16, s16, s3
    s_bitcmp1_b32 s40, 3
    s_cselect_b32 s3, 0x49400, 0
    s_xor_b32 s16, s16, s3
    s_bitcmp1_b32 s40, 4
    s_cselect_b32 s3, 0x8400, 0
    s_xor_b32 s16, s16, s3
    s_bitcmp1_b32 s40, 5
    s_cselect_b32 s3, 0x49000, 0
    s_xor_b32 s16, s16, s3
    s_bitcmp1_b32 s40, 6
    s_cselect_b32 s3, 0x8c00, 0
    s_xor_b32 s16, s16, s3
    s_bitcmp1_b32 s40, 7
    s_cselect_b32 s3, 0xc00, 0
    s_xor_b32 s16, s16, s3
    s_bitcmp1_b32 s7, 0
    s_cselect_b32 s20, 0x80000, 0
    s_xor_b32 s20, s20, s16
    s_bitcmp1_b32 s7, 1
    s_cselect_b32 s17, 0x400, 0
    s_xor_b32 s20, s20, s17
    s_bitcmp1_b32 s7, 2
    s_cselect_b32 s17, 0x1c9c00, 0
    s_xor_b32 s20, s20, s17
    s_bitcmp1_b32 s7, 3
    s_cselect_b32 s17, 0x4000, 0
    s_xor_b32 s20, s20, s17
    s_add_u32 s7, s7, 1
    s_mov_b32 s14, 0x200000
    s_mov_b32 s15, 0x20000
    s_waitcnt lgkmcnt(0)
    s_mov_b64 s[66:67], s[12:13]
    s_add_u32 s12, s58, s6
    s_addc_u32 s13, s59, 0
    s_barrier
    buffer_load_dwordx4 v[72:75], v68, s[12:15], s20 offen offset:0 nt
    buffer_load_dwordx4 v[80:83], v69, s[12:15], s20 offen offset:0 nt
    buffer_load_dwordx4 v[76:79], v68, s[12:15], s20 offen offset:256 nt
    buffer_load_dwordx4 v[84:87], v69, s[12:15], s20 offen offset:256 nt
    buffer_load_dwordx4 v[88:91], v70, s[12:15], s20 offen offset:0 nt
    buffer_load_dwordx4 v[96:99], v71, s[12:15], s20 offen offset:0 nt
    buffer_load_dwordx4 v[92:95], v70, s[12:15], s20 offen offset:256 nt
    s_add_u32 s58, s60, s6
    s_addc_u32 s59, s61, 0
    s_add_u32 s60, s68, s6
    s_addc_u32 s61, s69, 0
    s_add_u32 s62, s70, s6
    s_addc_u32 s63, s71, 0
    s_mov_b64 s[28:29], s[64:65]
    v_lshlrev_b32 v65, 4, v4
    v_bfe_u32 v6, v0, 3, 1
    v_lshlrev_b32 v6, 6, v6
    v_lshl_add_u32 v61, v5, 4, v6
    s_lshl_b32 s3, s44, 7
    s_add_u32 s3, s3, 65600
    v_add_u32 v61, s3, v61
    v_and_b32 v4, 7, v0
    v_and_b32 v5, 1, v4
    v_lshlrev_b32 v5, 4, v5
    v_mov_b32 v6, 0xffff
    v_lshlrev_b32 v6, v5, v6
    v_lshrrev_b32 v4, 1, v4
    v_cmp_eq_u32 vcc, 0, v4
    s_nop 1
    v_cndmask_b32 v56, 0, v6, vcc
    v_cmp_eq_u32 vcc, 1, v4
    s_nop 1
    v_cndmask_b32 v57, 0, v6, vcc
    v_cmp_eq_u32 vcc, 2, v4
    s_nop 1
    v_cndmask_b32 v58, 0, v6, vcc
    v_cmp_eq_u32 vcc, 3, v4
    s_nop 1
    v_cndmask_b32 v59, 0, v6, vcc
    v_mov_b32 v2, 1
    v_mov_b32 v3, 63488
    s_mov_b32 s22, 0x3db8aa3b
    s_mov_b32 s18, 0x01010101
    s_mov_b32 s19, 0x01010101
    s_mov_b32 s23, 64
    s_lshl_b32 s50, s44, 8
    s_add_u32 s50, s50, 63552
    s_lshl_b32 s51, s44, 11
    s_add_u32 s51, s51, 81984
    s_mul_i32 s54, s41, 37
    s_lshr_b32 s54, s54, 8
    s_mul_i32 s3, s54, 7
    s_sub_u32 s55, s41, s3
    v_lshrrev_b32 v7, 3, v0
    v_mul_u32_u24 v7, 896, v7
    v_and_b32 v8, 7, v0
    v_lshl_add_u32 v248, v8, 4, v7
    v_xor_b32 v249, 32, v248
    v_xor_b32 v250, 64, v248
    v_xor_b32 v251, 96, v248
    s_lshl_b32 s48, s43, 3
    s_and_b32 s3, s54, 2
    s_lshl_b32 s3, s3, 1
    s_add_u32 s48, s48, s3
    s_and_b32 s3, s54, 1
    s_add_u32 s48, s48, s3
    s_mul_i32 s48, s48, 64*896
    s_lshl_b32 s3, s55, 7
    s_add_u32 s48, s48, s3
    s_cmp_ge_u32 s41, 28
    s_cselect_b32 s30, 0, 3670016
    s_mov_b32 s31, 0x20000
    s_waitcnt vmcnt(6)
    buffer_load_dwordx4 v[100:103], v71, s[12:15], s20 offen offset:256 nt
    s_bitcmp1_b32 s7, 0
    s_cselect_b32 s20, 0x80000, 0
    s_xor_b32 s20, s20, s16
    s_bitcmp1_b32 s7, 1
    s_cselect_b32 s17, 0x400, 0
    s_xor_b32 s20, s20, s17
    s_bitcmp1_b32 s7, 2
    s_cselect_b32 s17, 0x1c9c00, 0
    s_xor_b32 s20, s20, s17
    s_bitcmp1_b32 s7, 3
    s_cselect_b32 s17, 0x4000, 0
    s_xor_b32 s20, s20, s17
    s_add_u32 s7, s7, 1
    s_waitcnt vmcnt(6)
    buffer_load_dwordx4 v[104:107], v68, s[12:15], s20 offen offset:0 nt
    s_waitcnt vmcnt(6)
    buffer_load_dwordx4 v[112:115], v69, s[12:15], s20 offen offset:0 nt
    s_waitcnt vmcnt(6)
    buffer_load_dwordx4 v[108:111], v68, s[12:15], s20 offen offset:256 nt
    s_waitcnt vmcnt(6)
    buffer_load_dwordx4 v[116:119], v69, s[12:15], s20 offen offset:256 nt
    s_waitcnt vmcnt(6)
    buffer_load_dwordx4 v[120:123], v70, s[12:15], s20 offen offset:0 nt
    s_waitcnt vmcnt(6)
    buffer_load_dwordx4 v[128:131], v71, s[12:15], s20 offen offset:0 nt
    s_waitcnt vmcnt(6)
    buffer_load_dwordx4 v[124:127], v70, s[12:15], s20 offen offset:256 nt
    s_waitcnt vmcnt(6)
    buffer_load_dwordx4 v[132:135], v71, s[12:15], s20 offen offset:256 nt
    s_bitcmp1_b32 s7, 0
    s_cselect_b32 s20, 0x80000, 0
    s_xor_b32 s20, s20, s16
    s_bitcmp1_b32 s7, 1
    s_cselect_b32 s17, 0x400, 0
    s_xor_b32 s20, s20, s17
    s_bitcmp1_b32 s7, 2
    s_cselect_b32 s17, 0x1c9c00, 0
    s_xor_b32 s20, s20, s17
    s_bitcmp1_b32 s7, 3
    s_cselect_b32 s17, 0x4000, 0
    s_xor_b32 s20, s20, s17
    s_add_u32 s7, s7, 1
    s_waitcnt vmcnt(6)
    buffer_load_dwordx4 v[136:139], v68, s[12:15], s20 offen offset:0 nt
    s_waitcnt vmcnt(6)
    buffer_load_dwordx4 v[144:147], v69, s[12:15], s20 offen offset:0 nt
    s_waitcnt vmcnt(6)
    buffer_load_dwordx4 v[140:143], v68, s[12:15], s20 offen offset:256 nt
    s_waitcnt vmcnt(6)
    buffer_load_dwordx4 v[148:151], v69, s[12:15], s20 offen offset:256 nt
    s_waitcnt vmcnt(6)
    buffer_load_dwordx4 v[152:155], v70, s[12:15], s20 offen offset:0 nt
    s_waitcnt vmcnt(6)
    buffer_load_dwordx4 v[160:163], v71, s[12:15], s20 offen offset:0 nt
    s_waitcnt vmcnt(6)
    buffer_load_dwordx4 v[156:159], v70, s[12:15], s20 offen offset:256 nt
    s_waitcnt vmcnt(6)
    buffer_load_dwordx4 v[164:167], v71, s[12:15], s20 offen offset:256 nt
    s_bitcmp1_b32 s7, 0
    s_cselect_b32 s20, 0x80000, 0
    s_xor_b32 s20, s20, s16
    s_bitcmp1_b32 s7, 1
    s_cselect_b32 s17, 0x400, 0
    s_xor_b32 s20, s20, s17
    s_bitcmp1_b32 s7, 2
    s_cselect_b32 s17, 0x1c9c00, 0
    s_xor_b32 s20, s20, s17
    s_bitcmp1_b32 s7, 3
    s_cselect_b32 s17, 0x4000, 0
    s_xor_b32 s20, s20, s17
    s_add_u32 s7, s7, 1
    s_waitcnt vmcnt(6)
    buffer_load_dwordx4 v[168:171], v68, s[12:15], s20 offen offset:0 nt
    s_waitcnt vmcnt(6)
    buffer_load_dwordx4 v[176:179], v69, s[12:15], s20 offen offset:0 nt
    s_waitcnt vmcnt(6)
    buffer_load_dwordx4 v[172:175], v68, s[12:15], s20 offen offset:256 nt
    s_waitcnt vmcnt(6)
    buffer_load_dwordx4 v[180:183], v69, s[12:15], s20 offen offset:256 nt
    s_waitcnt vmcnt(6)
    buffer_load_dwordx4 v[184:187], v70, s[12:15], s20 offen offset:0 nt
    s_waitcnt vmcnt(6)
    buffer_load_dwordx4 v[192:195], v71, s[12:15], s20 offen offset:0 nt
    s_waitcnt vmcnt(6)
    buffer_load_dwordx4 v[188:191], v70, s[12:15], s20 offen offset:256 nt
    s_waitcnt vmcnt(6)
    buffer_load_dwordx4 v[196:199], v71, s[12:15], s20 offen offset:256 nt
    s_bitcmp1_b32 s7, 0
    s_cselect_b32 s20, 0x80000, 0
    s_xor_b32 s20, s20, s16
    s_bitcmp1_b32 s7, 1
    s_cselect_b32 s17, 0x400, 0
    s_xor_b32 s20, s20, s17
    s_bitcmp1_b32 s7, 2
    s_cselect_b32 s17, 0x1c9c00, 0
    s_xor_b32 s20, s20, s17
    s_bitcmp1_b32 s7, 3
    s_cselect_b32 s17, 0x4000, 0
    s_xor_b32 s20, s20, s17
    s_add_u32 s7, s7, 1
    s_barrier
    s_mov_b64 vcc, 0
L_newp:
    ds_read_b128 v[4:7], v65 offset:61440
    ds_read_b128 v[8:11], v65 offset:61696
    ds_read_b128 v[12:15], v65 offset:61952
    ds_read_b128 v[16:19], v65 offset:62208
    v_mov_b32 v60, 0xff800000
    v_mov_b32 v28, 0
    v_mov_b32 v29, 0
    v_mov_b32 v30, 0
    v_mov_b32 v31, 0
    v_mov_b32 v32, 0
    v_mov_b32 v33, 0
    v_mov_b32 v34, 0
    v_mov_b32 v35, 0
    v_add_u32 v65, 1024, v65
    v_mov_b32 v64, v61
    s_mov_b32 s21, 4
    s_waitcnt lgkmcnt(0)
    s_cmp_lg_u32 s23, 64
    s_cbranch_scc1 L_k0
    ds_read_b32 v66, v3 offset:24
    v_dot2_f32_bf16 v20, v72, v4, 0
    v_dot2_f32_bf16 v21, v72, v12, 0
    v_dot2_f32_bf16 v22, v80, v4, 0
    v_dot2_f32_bf16 v23, v80, v12, 0
    v_dot2_f32_bf16 v24, v88, v4, 0
    v_dot2_f32_bf16 v25, v88, v12, 0
    v_dot2_f32_bf16 v26, v96, v4, 0
    v_dot2_f32_bf16 v27, v96, v12, 0
    v_dot2c_f32_bf16 v20, v73, v5
    v_dot2c_f32_bf16 v21, v73, v13
    v_dot2c_f32_bf16 v22, v81, v5
    v_dot2c_f32_bf16 v23, v81, v13
    v_dot2c_f32_bf16 v24, v89, v5
    v_dot2c_f32_bf16 v25, v89, v13
    v_dot2c_f32_bf16 v26, v97, v5
    v_dot2c_f32_bf16 v27, v97, v13
    v_dot2c_f32_bf16 v20, v74, v6
    v_dot2c_f32_bf16 v21, v74, v14
    v_dot2c_f32_bf16 v22, v82, v6
    v_dot2c_f32_bf16 v23, v82, v14
    v_dot2c_f32_bf16 v24, v90, v6
    v_dot2c_f32_bf16 v25, v90, v14
    v_dot2c_f32_bf16 v26, v98, v6
    v_dot2c_f32_bf16 v27, v98, v14
    v_dot2c_f32_bf16 v20, v75, v7
    v_dot2c_f32_bf16 v21, v75, v15
    v_dot2c_f32_bf16 v22, v83, v7
    v_dot2c_f32_bf16 v23, v83, v15
    v_dot2c_f32_bf16 v24, v91, v7
    v_dot2c_f32_bf16 v25, v91, v15
    v_dot2c_f32_bf16 v26, v99, v7
    v_dot2c_f32_bf16 v27, v99, v15
    v_dot2c_f32_bf16 v20, v76, v8
    v_dot2c_f32_bf16 v21, v76, v16
    v_dot2c_f32_bf16 v22, v84, v8
    v_dot2c_f32_bf16 v23, v84, v16
    v_dot2c_f32_bf16 v24, v92, v8
    v_dot2c_f32_bf16 v25, v92, v16
    v_dot2c_f32_bf16 v26, v100, v8
    v_dot2c_f32_bf16 v27, v100, v16
    v_dot2c_f32_bf16 v20, v77, v9
    v_dot2c_f32_bf16 v21, v77, v17
    v_dot2c_f32_bf16 v22, v85, v9
    v_dot2c_f32_bf16 v23, v85, v17
    v_dot2c_f32_bf16 v24, v93, v9
    v_dot2c_f32_bf16 v25, v93, v17
    v_dot2c_f32_bf16 v26, v101, v9
    v_dot2c_f32_bf16 v27, v101, v17
    v_dot2c_f32_bf16 v20, v78, v10
    v_dot2c_f32_bf16 v21, v78, v18
    v_dot2c_f32_bf16 v22, v86, v10
    v_dot2c_f32_bf16 v23, v86, v18
    v_dot2c_f32_bf16 v24, v94, v10
    v_dot2c_f32_bf16 v25, v94, v18
    v_dot2c_f32_bf16 v26, v102, v10
    v_dot2c_f32_bf16 v27, v102, v18
    v_dot2c_f32_bf16 v20, v79, v11
    v_dot2c_f32_bf16 v21, v79, v19
    v_dot2c_f32_bf16 v22, v87, v11
    v_dot2c_f32_bf16 v23, v87, v19
    v_dot2c_f32_bf16 v24, v95, v11
    v_dot2c_f32_bf16 v25, v95, v19
    v_dot2c_f32_bf16 v26, v103, v11
    v_dot2c_f32_bf16 v27, v103, v19
    s_waitcnt lgkmcnt(0)
    v_cmp_ne_u32 vcc, 0, v66
    v_add_f32_dpp v36, v20, v20 row_ror:8 row_mask:0xf bank_mask:0x3
    v_add_f32_dpp v37, v22, v22 row_ror:8 row_mask:0xf bank_mask:0x3
    v_add_f32_dpp v38, v24, v24 row_ror:8 row_mask:0xf bank_mask:0x3
    v_add_f32_dpp v39, v26, v26 row_ror:8 row_mask:0xf bank_mask:0x3
    v_add_f32_dpp v36, v21, v21 row_ror:8 row_mask:0xf bank_mask:0xc
    v_add_f32_dpp v37, v23, v23 row_ror:8 row_mask:0xf bank_mask:0xc
    v_add_f32_dpp v38, v25, v25 row_ror:8 row_mask:0xf bank_mask:0xc
    v_add_f32_dpp v39, v27, v27 row_ror:8 row_mask:0xf bank_mask:0xc
    v_add_f32_dpp v36, v36, v36 row_half_mirror row_mask:0xf bank_mask:0xf
    v_add_f32_dpp v37, v37, v37 row_half_mirror row_mask:0xf bank_mask:0xf
    v_add_f32_dpp v38, v38, v38 row_half_mirror row_mask:0xf bank_mask:0xf
    v_add_f32_dpp v39, v39, v39 row_half_mirror row_mask:0xf bank_mask:0xf
    v_add_f32_dpp v36, v36, v36 quad_perm:[1,0,3,2] row_mask:0xf bank_mask:0xf
    v_add_f32_dpp v37, v37, v37 quad_perm:[1,0,3,2] row_mask:0xf bank_mask:0xf
    v_add_f32_dpp v38, v38, v38 quad_perm:[1,0,3,2] row_mask:0xf bank_mask:0xf
    v_add_f32_dpp v39, v39, v39 quad_perm:[1,0,3,2] row_mask:0xf bank_mask:0xf
    v_add_f32_dpp v36, v36, v36 quad_perm:[2,3,0,1] row_mask:0xf bank_mask:0xf
    v_add_f32_dpp v37, v37, v37 quad_perm:[2,3,0,1] row_mask:0xf bank_mask:0xf
    v_add_f32_dpp v38, v38, v38 quad_perm:[2,3,0,1] row_mask:0xf bank_mask:0xf
    v_add_f32_dpp v39, v39, v39 quad_perm:[2,3,0,1] row_mask:0xf bank_mask:0xf
    v_max3_f32 v60, v60, v36, v37
    v_max3_f32 v60, v60, v38, v39
    s_mov_b64 exec, s[18:19]
    ds_write_b128 v64, v[36:39] offset:0
    s_mov_b64 exec, -1
    s_branch L_k1
L_k0:
    s_waitcnt vmcnt(5)
    s_cbranch_vccnz L_w1
    s_waitcnt vmcnt(4)
L_w1:
    buffer_load_dwordx4 v[168:171], v68, s[12:15], s20 offen offset:0 nt
    ds_read_b32 v66, v3 offset:24
    v_dot2_f32_bf16 v20, v72, v4, 0
    v_dot2_f32_bf16 v21, v72, v12, 0
    v_dot2_f32_bf16 v22, v80, v4, 0
    v_dot2_f32_bf16 v23, v80, v12, 0
    v_dot2_f32_bf16 v24, v88, v4, 0
    v_dot2_f32_bf16 v25, v88, v12, 0
    v_dot2_f32_bf16 v26, v96, v4, 0
    v_dot2_f32_bf16 v27, v96, v12, 0
    v_dot2c_f32_bf16 v20, v73, v5
    v_dot2c_f32_bf16 v21, v73, v13
    s_waitcnt vmcnt(6)
    s_cbranch_vccnz L_w2
    s_waitcnt vmcnt(4)
L_w2:
    buffer_load_dwordx4 v[176:179], v69, s[12:15], s20 offen offset:0 nt
    v_dot2c_f32_bf16 v22, v81, v5
    v_dot2c_f32_bf16 v23, v81, v13
    v_dot2c_f32_bf16 v24, v89, v5
    v_dot2c_f32_bf16 v25, v89, v13
    v_dot2c_f32_bf16 v26, v97, v5
    v_dot2c_f32_bf16 v27, v97, v13
    v_dot2c_f32_bf16 v20, v74, v6
    v_dot2c_f32_bf16 v21, v74, v14
    v_dot2c_f32_bf16 v22, v82, v6
    v_dot2c_f32_bf16 v23, v82, v14
    v_dot2c_f32_bf16 v24, v90, v6
    s_waitcnt vmcnt(5)
    s_cbranch_vccnz L_w3
    s_waitcnt vmcnt(4)
L_w3:
    buffer_load_dwordx4 v[172:175], v68, s[12:15], s20 offen offset:256 nt
    v_dot2c_f32_bf16 v25, v90, v14
    v_dot2c_f32_bf16 v26, v98, v6
    v_dot2c_f32_bf16 v27, v98, v14
    v_dot2c_f32_bf16 v20, v75, v7
    v_dot2c_f32_bf16 v21, v75, v15
    v_dot2c_f32_bf16 v22, v83, v7
    v_dot2c_f32_bf16 v23, v83, v15
    v_dot2c_f32_bf16 v24, v91, v7
    v_dot2c_f32_bf16 v25, v91, v15
    v_dot2c_f32_bf16 v26, v99, v7
    v_dot2c_f32_bf16 v27, v99, v15
    s_waitcnt vmcnt(6)
    s_cbranch_vccnz L_w4
    s_waitcnt vmcnt(4)
L_w4:
    buffer_load_dwordx4 v[180:183], v69, s[12:15], s20 offen offset:256 nt
    v_dot2c_f32_bf16 v20, v76, v8
    v_dot2c_f32_bf16 v21, v76, v16
    v_dot2c_f32_bf16 v22, v84, v8
    v_dot2c_f32_bf16 v23, v84, v16
    v_dot2c_f32_bf16 v24, v92, v8
    v_dot2c_f32_bf16 v25, v92, v16
    v_dot2c_f32_bf16 v26, v100, v8
    v_dot2c_f32_bf16 v27, v100, v16
    v_dot2c_f32_bf16 v20, v77, v9
    v_dot2c_f32_bf16 v21, v77, v17
    v_dot2c_f32_bf16 v22, v85, v9
    s_waitcnt vmcnt(5)
    s_cbranch_vccnz L_w5
    s_waitcnt vmcnt(4)
L_w5:
    buffer_load_dwordx4 v[184:187], v70, s[12:15], s20 offen offset:0 nt
    v_dot2c_f32_bf16 v23, v85, v17
    v_dot2c_f32_bf16 v24, v93, v9
    v_dot2c_f32_bf16 v25, v93, v17
    v_dot2c_f32_bf16 v26, v101, v9
    v_dot2c_f32_bf16 v27, v101, v17
    v_dot2c_f32_bf16 v20, v78, v10
    v_dot2c_f32_bf16 v21, v78, v18
    v_dot2c_f32_bf16 v22, v86, v10
    v_dot2c_f32_bf16 v23, v86, v18
    v_dot2c_f32_bf16 v24, v94, v10
    v_dot2c_f32_bf16 v25, v94, v18
    s_waitcnt vmcnt(6)
    s_cbranch_vccnz L_w6
    s_waitcnt vmcnt(4)
L_w6:
    buffer_load_dwordx4 v[192:195], v71, s[12:15], s20 offen offset:0 nt
    v_dot2c_f32_bf16 v26, v102, v10
    v_dot2c_f32_bf16 v27, v102, v18
    v_dot2c_f32_bf16 v20, v79, v11
    v_dot2c_f32_bf16 v21, v79, v19
    v_dot2c_f32_bf16 v22, v87, v11
    v_dot2c_f32_bf16 v23, v87, v19
    v_dot2c_f32_bf16 v24, v95, v11
    v_dot2c_f32_bf16 v25, v95, v19
    v_dot2c_f32_bf16 v26, v103, v11
    v_dot2c_f32_bf16 v27, v103, v19
    s_waitcnt lgkmcnt(0)
    v_cmp_ne_u32 vcc, 0, v66
    s_waitcnt vmcnt(5)
    s_cbranch_vccnz L_w7
    s_waitcnt vmcnt(4)
L_w7:
    buffer_load_dwordx4 v[188:191], v70, s[12:15], s20 offen offset:256 nt
    v_add_f32_dpp v36, v20, v20 row_ror:8 row_mask:0xf bank_mask:0x3
    v_add_f32_dpp v37, v22, v22 row_ror:8 row_mask:0xf bank_mask:0x3
    v_add_f32_dpp v38, v24, v24 row_ror:8 row_mask:0xf bank_mask:0x3
    v_add_f32_dpp v39, v26, v26 row_ror:8 row_mask:0xf bank_mask:0x3
    v_add_f32_dpp v36, v21, v21 row_ror:8 row_mask:0xf bank_mask:0xc
    v_add_f32_dpp v37, v23, v23 row_ror:8 row_mask:0xf bank_mask:0xc
    v_add_f32_dpp v38, v25, v25 row_ror:8 row_mask:0xf bank_mask:0xc
    v_add_f32_dpp v39, v27, v27 row_ror:8 row_mask:0xf bank_mask:0xc
    v_add_f32_dpp v36, v36, v36 row_half_mirror row_mask:0xf bank_mask:0xf
    v_add_f32_dpp v37, v37, v37 row_half_mirror row_mask:0xf bank_mask:0xf
    v_add_f32_dpp v38, v38, v38 row_half_mirror row_mask:0xf bank_mask:0xf
    s_waitcnt vmcnt(6)
    s_cbranch_vccnz L_w8
    s_waitcnt vmcnt(4)
L_w8:
    buffer_load_dwordx4 v[196:199], v71, s[12:15], s20 offen offset:256 nt
    s_bitcmp1_b32 s7, 0
    s_cselect_b32 s20, 0x80000, 0
    s_xor_b32 s20, s20, s16
    s_bitcmp1_b32 s7, 1
    s_cselect_b32 s17, 0x400, 0
    s_xor_b32 s20, s20, s17
    s_bitcmp1_b32 s7, 2
    s_cselect_b32 s17, 0x1c9c00, 0
    s_xor_b32 s20, s20, s17
    s_bitcmp1_b32 s7, 3
    s_cselect_b32 s17, 0x4000, 0
    s_xor_b32 s20, s20, s17
    s_add_u32 s7, s7, 1
    v_add_f32_dpp v39, v39, v39 row_half_mirror row_mask:0xf bank_mask:0xf
    v_add_f32_dpp v36, v36, v36 quad_perm:[1,0,3,2] row_mask:0xf bank_mask:0xf
    v_add_f32_dpp v37, v37, v37 quad_perm:[1,0,3,2] row_mask:0xf bank_mask:0xf
    v_add_f32_dpp v38, v38, v38 quad_perm:[1,0,3,2] row_mask:0xf bank_mask:0xf
    v_add_f32_dpp v39, v39, v39 quad_perm:[1,0,3,2] row_mask:0xf bank_mask:0xf
    v_add_f32_dpp v36, v36, v36 quad_perm:[2,3,0,1] row_mask:0xf bank_mask:0xf
    v_add_f32_dpp v37, v37, v37 quad_perm:[2,3,0,1] row_mask:0xf bank_mask:0xf
    v_add_f32_dpp v38, v38, v38 quad_perm:[2,3,0,1] row_mask:0xf bank_mask:0xf
    v_add_f32_dpp v39, v39, v39 quad_perm:[2,3,0,1] row_mask:0xf bank_mask:0xf
    v_max3_f32 v60, v60, v36, v37
    v_max3_f32 v60, v60, v38, v39
    s_mov_b64 exec, s[18:19]
    ds_write_b128 v64, v[36:39] offset:0
    s_mov_b64 exec, -1
L_k1:
    s_cmp_eq_u32 s21, 1
    s_cselect_b64 s[12:13], s[58:59], s[12:13]
    s_waitcnt vmcnt(5)
    s_cbranch_vccnz L_w9
    s_waitcnt vmcnt(4)
L_w9:
    buffer_load_dwordx4 v[72:75], v68, s[12:15], s20 offen offset:0 nt
    ds_read_b32 v66, v3 offset:24
    v_dot2_f32_bf16 v20, v104, v4, 0
    v_dot2_f32_bf16 v21, v104, v12, 0
    v_dot2_f32_bf16 v22, v112, v4, 0
    v_dot2_f32_bf16 v23, v112, v12, 0
    v_dot2_f32_bf16 v24, v120, v4, 0
    v_dot2_f32_bf16 v25, v120, v12, 0
    v_dot2_f32_bf16 v26, v128, v4, 0
    v_dot2_f32_bf16 v27, v128, v12, 0
    v_dot2c_f32_bf16 v20, v105, v5
    v_dot2c_f32_bf16 v21, v105, v13
    s_waitcnt vmcnt(6)
    s_cbranch_vccnz L_w10
    s_waitcnt vmcnt(4)
L_w10:
    buffer_load_dwordx4 v[80:83], v69, s[12:15], s20 offen offset:0 nt
    v_dot2c_f32_bf16 v22, v113, v5
    v_dot2c_f32_bf16 v23, v113, v13
    v_dot2c_f32_bf16 v24, v121, v5
    v_dot2c_f32_bf16 v25, v121, v13
    v_dot2c_f32_bf16 v26, v129, v5
    v_dot2c_f32_bf16 v27, v129, v13
    v_dot2c_f32_bf16 v20, v106, v6
    v_dot2c_f32_bf16 v21, v106, v14
    v_dot2c_f32_bf16 v22, v114, v6
    v_dot2c_f32_bf16 v23, v114, v14
    v_dot2c_f32_bf16 v24, v122, v6
    s_waitcnt vmcnt(5)
    s_cbranch_vccnz L_w11
    s_waitcnt vmcnt(4)
L_w11:
    buffer_load_dwordx4 v[76:79], v68, s[12:15], s20 offen offset:256 nt
    v_dot2c_f32_bf16 v25, v122, v14
    v_dot2c_f32_bf16 v26, v130, v6
    v_dot2c_f32_bf16 v27, v130, v14
    v_dot2c_f32_bf16 v20, v107, v7
    v_dot2c_f32_bf16 v21, v107, v15
    v_dot2c_f32_bf16 v22, v115, v7
    v_dot2c_f32_bf16 v23, v115, v15
    v_dot2c_f32_bf16 v24, v123, v7
    v_dot2c_f32_bf16 v25, v123, v15
    v_dot2c_f32_bf16 v26, v131, v7
    v_dot2c_f32_bf16 v27, v131, v15
    s_waitcnt vmcnt(6)
    s_cbranch_vccnz L_w12
    s_waitcnt vmcnt(4)
L_w12:
    buffer_load_dwordx4 v[84:87], v69, s[12:15], s20 offen offset:256 nt
    v_dot2c_f32_bf16 v20, v108, v8
    v_dot2c_f32_bf16 v21, v108, v16
    v_dot2c_f32_bf16 v22, v116, v8
    v_dot2c_f32_bf16 v23, v116, v16
    v_dot2c_f32_bf16 v24, v124, v8
    v_dot2c_f32_bf16 v25, v124, v16
    v_dot2c_f32_bf16 v26, v132, v8
    v_dot2c_f32_bf16 v27, v132, v16
    v_dot2c_f32_bf16 v20, v109, v9
    v_dot2c_f32_bf16 v21, v109, v17
    v_dot2c_f32_bf16 v22, v117, v9
    s_waitcnt vmcnt(5)
    s_cbranch_vccnz L_w13
    s_waitcnt vmcnt(4)
L_w13:
    buffer_load_dwordx4 v[88:91], v70, s[12:15], s20 offen offset:0 nt
    v_dot2c_f32_bf16 v23, v117, v17
    v_dot2c_f32_bf16 v24, v125, v9
    v_dot2c_f32_bf16 v25, v125, v17
    v_dot2c_f32_bf16 v26, v133, v9
    v_dot2c_f32_bf16 v27, v133, v17
    v_dot2c_f32_bf16 v20, v110, v10
    v_dot2c_f32_bf16 v21, v110, v18
    v_dot2c_f32_bf16 v22, v118, v10
    v_dot2c_f32_bf16 v23, v118, v18
    v_dot2c_f32_bf16 v24, v126, v10
    v_dot2c_f32_bf16 v25, v126, v18
    s_waitcnt vmcnt(6)
    s_cbranch_vccnz L_w14
    s_waitcnt vmcnt(4)
L_w14:
    buffer_load_dwordx4 v[96:99], v71, s[12:15], s20 offen offset:0 nt
    v_dot2c_f32_bf16 v26, v134, v10
    v_dot2c_f32_bf16 v27, v134, v18
    v_dot2c_f32_bf16 v20, v111, v11
    v_dot2c_f32_bf16 v21, v111, v19
    v_dot2c_f32_bf16 v22, v119, v11
    v_dot2c_f32_bf16 v23, v119, v19
    v_dot2c_f32_bf16 v24, v127, v11
    v_dot2c_f32_bf16 v25, v127, v19
    v_dot2c_f32_bf16 v26, v135, v11
    v_dot2c_f32_bf16 v27, v135, v19
    s_waitcnt lgkmcnt(0)
    v_cmp_ne_u32 vcc, 0, v66
    s_waitcnt vmcnt(5)
    s_cbranch_vccnz L_w15
    s_waitcnt vmcnt(4)
L_w15:
    buffer_load_dwordx4 v[92:95], v70, s[12:15], s20 offen offset:256 nt
    v_add_f32_dpp v36, v20, v20 row_ror:8 row_mask:0xf bank_mask:0x3
    v_add_f32_dpp v37, v22, v22 row_ror:8 row_mask:0xf bank_mask:0x3
    v_add_f32_dpp v38, v24, v24 row_ror:8 row_mask:0xf bank_mask:0x3
    v_add_f32_dpp v39, v26, v26 row_ror:8 row_mask:0xf bank_mask:0x3
    v_add_f32_dpp v36, v21, v21 row_ror:8 row_mask:0xf bank_mask:0xc
    v_add_f32_dpp v37, v23, v23 row_ror:8 row_mask:0xf bank_mask:0xc
    v_add_f32_dpp v38, v25, v25 row_ror:8 row_mask:0xf bank_mask:0xc
    v_add_f32_dpp v39, v27, v27 row_ror:8 row_mask:0xf bank_mask:0xc
    v_add_f32_dpp v36, v36, v36 row_half_mirror row_mask:0xf bank_mask:0xf
    v_add_f32_dpp v37, v37, v37 row_half_mirror row_mask:0xf bank_mask:0xf
    v_add_f32_dpp v38, v38, v38 row_half_mirror row_mask:0xf bank_mask:0xf
    s_waitcnt vmcnt(6)
    s_cbranch_vccnz L_w16
    s_waitcnt vmcnt(4)
L_w16:
    buffer_load_dwordx4 v[100:103], v71, s[12:15], s20 offen offset:256 nt
    s_bitcmp1_b32 s7, 0
    s_cselect_b32 s20, 0x80000, 0
    s_xor_b32 s20, s20, s16
    s_bitcmp1_b32 s7, 1
    s_cselect_b32 s17, 0x400, 0
    s_xor_b32 s20, s20, s17
    s_bitcmp1_b32 s7, 2
    s_cselect_b32 s17, 0x1c9c00, 0
    s_xor_b32 s20, s20, s17
    s_bitcmp1_b32 s7, 3
    s_cselect_b32 s17, 0x4000, 0
    s_xor_b32 s20, s20, s17
    s_add_u32 s7, s7, 1
    v_add_f32_dpp v39, v39, v39 row_half_mirror row_mask:0xf bank_mask:0xf
    v_add_f32_dpp v36, v36, v36 quad_perm:[1,0,3,2] row_mask:0xf bank_mask:0xf
    v_add_f32_dpp v37, v37, v37 quad_perm:[1,0,3,2] row_mask:0xf bank_mask:0xf
    v_add_f32_dpp v38, v38, v38 quad_perm:[1,0,3,2] row_mask:0xf bank_mask:0xf
    v_add_f32_dpp v39, v39, v39 quad_perm:[1,0,3,2] row_mask:0xf bank_mask:0xf
    v_add_f32_dpp v36, v36, v36 quad_perm:[2,3,0,1] row_mask:0xf bank_mask:0xf
    v_add_f32_dpp v37, v37, v37 quad_perm:[2,3,0,1] row_mask:0xf bank_mask:0xf
    v_add_f32_dpp v38, v38, v38 quad_perm:[2,3,0,1] row_mask:0xf bank_mask:0xf
    v_add_f32_dpp v39, v39, v39 quad_perm:[2,3,0,1] row_mask:0xf bank_mask:0xf
    v_max3_f32 v60, v60, v36, v37
    v_max3_f32 v60, v60, v38, v39
    s_mov_b64 exec, s[18:19]
    ds_write_b128 v64, v[36:39] offset:512
    s_mov_b64 exec, -1
L_k2:
    s_waitcnt vmcnt(5)
    s_cbranch_vccnz L_w17
    s_waitcnt vmcnt(4)
L_w17:
    buffer_load_dwordx4 v[104:107], v68, s[12:15], s20 offen offset:0 nt
    ds_read_b32 v66, v3 offset:24
    v_dot2_f32_bf16 v20, v136, v4, 0
    v_dot2_f32_bf16 v21, v136, v12, 0
    v_dot2_f32_bf16 v22, v144, v4, 0
    v_dot2_f32_bf16 v23, v144, v12, 0
    v_dot2_f32_bf16 v24, v152, v4, 0
    v_dot2_f32_bf16 v25, v152, v12, 0
    v_dot2_f32_bf16 v26, v160, v4, 0
    v_dot2_f32_bf16 v27, v160, v12, 0
    v_dot2c_f32_bf16 v20, v137, v5
    v_dot2c_f32_bf16 v21, v137, v13
    s_waitcnt vmcnt(6)
    s_cbranch_vccnz L_w18
    s_waitcnt vmcnt(4)
L_w18:
    buffer_load_dwordx4 v[112:115], v69, s[12:15], s20 offen offset:0 nt
    v_dot2c_f32_bf16 v22, v145, v5
    v_dot2c_f32_bf16 v23, v145, v13
    v_dot2c_f32_bf16 v24, v153, v5
    v_dot2c_f32_bf16 v25, v153, v13
    v_dot2c_f32_bf16 v26, v161, v5
    v_dot2c_f32_bf16 v27, v161, v13
    v_dot2c_f32_bf16 v20, v138, v6
    v_dot2c_f32_bf16 v21, v138, v14
    v_dot2c_f32_bf16 v22, v146, v6
    v_dot2c_f32_bf16 v23, v146, v14
    v_dot2c_f32_bf16 v24, v154, v6
    s_waitcnt vmcnt(5)
    s_cbranch_vccnz L_w19
    s_waitcnt vmcnt(4)
L_w19:
    buffer_load_dwordx4 v[108:111], v68, s[12:15], s20 offen offset:256 nt
    v_dot2c_f32_bf16 v25, v154, v14
    v_dot2c_f32_bf16 v26, v162, v6
    v_dot2c_f32_bf16 v27, v162, v14
    v_dot2c_f32_bf16 v20, v139, v7
    v_dot2c_f32_bf16 v21, v139, v15
    v_dot2c_f32_bf16 v22, v147, v7
    v_dot2c_f32_bf16 v23, v147, v15
    v_dot2c_f32_bf16 v24, v155, v7
    v_dot2c_f32_bf16 v25, v155, v15
    v_dot2c_f32_bf16 v26, v163, v7
    v_dot2c_f32_bf16 v27, v163, v15
    s_waitcnt vmcnt(6)
    s_cbranch_vccnz L_w20
    s_waitcnt vmcnt(4)
L_w20:
    buffer_load_dwordx4 v[116:119], v69, s[12:15], s20 offen offset:256 nt
    v_dot2c_f32_bf16 v20, v140, v8
    v_dot2c_f32_bf16 v21, v140, v16
    v_dot2c_f32_bf16 v22, v148, v8
    v_dot2c_f32_bf16 v23, v148, v16
    v_dot2c_f32_bf16 v24, v156, v8
    v_dot2c_f32_bf16 v25, v156, v16
    v_dot2c_f32_bf16 v26, v164, v8
    v_dot2c_f32_bf16 v27, v164, v16
    v_dot2c_f32_bf16 v20, v141, v9
    v_dot2c_f32_bf16 v21, v141, v17
    v_dot2c_f32_bf16 v22, v149, v9
    s_waitcnt vmcnt(5)
    s_cbranch_vccnz L_w21
    s_waitcnt vmcnt(4)
L_w21:
    buffer_load_dwordx4 v[120:123], v70, s[12:15], s20 offen offset:0 nt
    v_dot2c_f32_bf16 v23, v149, v17
    v_dot2c_f32_bf16 v24, v157, v9
    v_dot2c_f32_bf16 v25, v157, v17
    v_dot2c_f32_bf16 v26, v165, v9
    v_dot2c_f32_bf16 v27, v165, v17
    v_dot2c_f32_bf16 v20, v142, v10
    v_dot2c_f32_bf16 v21, v142, v18
    v_dot2c_f32_bf16 v22, v150, v10
    v_dot2c_f32_bf16 v23, v150, v18
    v_dot2c_f32_bf16 v24, v158, v10
    v_dot2c_f32_bf16 v25, v158, v18
    s_waitcnt vmcnt(6)
    s_cbranch_vccnz L_w22
    s_waitcnt vmcnt(4)
L_w22:
    buffer_load_dwordx4 v[128:131], v71, s[12:15], s20 offen offset:0 nt
    v_dot2c_f32_bf16 v26, v166, v10
    v_dot2c_f32_bf16 v27, v166, v18
    v_dot2c_f32_bf16 v20, v143, v11
    v_dot2c_f32_bf16 v21, v143, v19
    v_dot2c_f32_bf16 v22, v151, v11
    v_dot2c_f32_bf16 v23, v151, v19
    v_dot2c_f32_bf16 v24, v159, v11
    v_dot2c_f32_bf16 v25, v159, v19
    v_dot2c_f32_bf16 v26, v167, v11
    v_dot2c_f32_bf16 v27, v167, v19
    s_waitcnt lgkmcnt(0)
    v_cmp_ne_u32 vcc, 0, v66
    s_waitcnt vmcnt(5)
    s_cbranch_vccnz L_w23
    s_waitcnt vmcnt(4)
L_w23:
    buffer_load_dwordx4 v[124:127], v70, s[12:15], s20 offen offset:256 nt
    v_add_f32_dpp v36, v20, v20 row_ror:8 row_mask:0xf bank_mask:0x3
    v_add_f32_dpp v37, v22, v22 row_ror:8 row_mask:0xf bank_mask:0x3
    v_add_f32_dpp v38, v24, v24 row_ror:8 row_mask:0xf bank_mask:0x3
    v_add_f32_dpp v39, v26, v26 row_ror:8 row_mask:0xf bank_mask:0x3
    v_add_f32_dpp v36, v21, v21 row_ror:8 row_mask:0xf bank_mask:0xc
    v_add_f32_dpp v37, v23, v23 row_ror:8 row_mask:0xf bank_mask:0xc
    v_add_f32_dpp v38, v25, v25 row_ror:8 row_mask:0xf bank_mask:0xc
    v_add_f32_dpp v39, v27, v27 row_ror:8 row_mask:0xf bank_mask:0xc
    v_add_f32_dpp v36, v36, v36 row_half_mirror row_mask:0xf bank_mask:0xf
    v_add_f32_dpp v37, v37, v37 row_half_mirror row_mask:0xf bank_mask:0xf
    v_add_f32_dpp v38, v38, v38 row_half_mirror row_mask:0xf bank_mask:0xf
    s_waitcnt vmcnt(6)
    s_cbranch_vccnz L_w24
    s_waitcnt vmcnt(4)
L_w24:
    buffer_load_dwordx4 v[132:135], v71, s[12:15], s20 offen offset:256 nt
    s_bitcmp1_b32 s7, 0
    s_cselect_b32 s20, 0x80000, 0
    s_xor_b32 s20, s20, s16
    s_bitcmp1_b32 s7, 1
    s_cselect_b32 s17, 0x400, 0
    s_xor_b32 s20, s20, s17
    s_bitcmp1_b32 s7, 2
    s_cselect_b32 s17, 0x1c9c00, 0
    s_xor_b32 s20, s20, s17
    s_bitcmp1_b32 s7, 3
    s_cselect_b32 s17, 0x4000, 0
    s_xor_b32 s20, s20, s17
    s_add_u32 s7, s7, 1
    v_add_f32_dpp v39, v39, v39 row_half_mirror row_mask:0xf bank_mask:0xf
    v_add_f32_dpp v36, v36, v36 quad_perm:[1,0,3,2] row_mask:0xf bank_mask:0xf
    v_add_f32_dpp v37, v37, v37 quad_perm:[1,0,3,2] row_mask:0xf bank_mask:0xf
    v_add_f32_dpp v38, v38, v38 quad_perm:[1,0,3,2] row_mask:0xf bank_mask:0xf
    v_add_f32_dpp v39, v39, v39 quad_perm:[1,0,3,2] row_mask:0xf bank_mask:0xf
    v_add_f32_dpp v36, v36, v36 quad_perm:[2,3,0,1] row_mask:0xf bank_mask:0xf
    v_add_f32_dpp v37, v37, v37 quad_perm:[2,3,0,1] row_mask:0xf bank_mask:0xf
    v_add_f32_dpp v38, v38, v38 quad_perm:[2,3,0,1] row_mask:0xf bank_mask:0xf
    v_add_f32_dpp v39, v39, v39 quad_perm:[2,3,0,1] row_mask:0xf bank_mask:0xf
    v_max3_f32 v60, v60, v36, v37
    v_max3_f32 v60, v60, v38, v39
    s_mov_b64 exec, s[18:19]
    ds_write_b128 v64, v[36:39] offset:1024
    s_mov_b64 exec, -1
L_k3:
    s_waitcnt vmcnt(5)
    s_cbranch_vccnz L_w25
    s_waitcnt vmcnt(4)
L_w25:
    buffer_load_dwordx4 v[136:139], v68, s[12:15], s20 offen offset:0 nt
    ds_read_b32 v66, v3 offset:24
    v_dot2_f32_bf16 v20, v168, v4, 0
    v_dot2_f32_bf16 v21, v168, v12, 0
    v_dot2_f32_bf16 v22, v176, v4, 0
    v_dot2_f32_bf16 v23, v176, v12, 0
    v_dot2_f32_bf16 v24, v184, v4, 0
    v_dot2_f32_bf16 v25, v184, v12, 0
    v_dot2_f32_bf16 v26, v192, v4, 0
    v_dot2_f32_bf16 v27, v192, v12, 0
    v_dot2c_f32_bf16 v20, v169, v5
    v_dot2c_f32_bf16 v21, v169, v13
    s_waitcnt vmcnt(6)
    s_cbranch_vccnz L_w26
    s_waitcnt vmcnt(4)
L_w26:
    buffer_load_dwordx4 v[144:147], v69, s[12:15], s20 offen offset:0 nt
    v_dot2c_f32_bf16 v22, v177, v5
    v_dot2c_f32_bf16 v23, v177, v13
    v_dot2c_f32_bf16 v24, v185, v5
    v_dot2c_f32_bf16 v25, v185, v13
    v_dot2c_f32_bf16 v26, v193, v5
    v_dot2c_f32_bf16 v27, v193, v13
    v_dot2c_f32_bf16 v20, v170, v6
    v_dot2c_f32_bf16 v21, v170, v14
    v_dot2c_f32_bf16 v22, v178, v6
    v_dot2c_f32_bf16 v23, v178, v14
    v_dot2c_f32_bf16 v24, v186, v6
    s_waitcnt vmcnt(5)
    s_cbranch_vccnz L_w27
    s_waitcnt vmcnt(4)
L_w27:
    buffer_load_dwordx4 v[140:143], v68, s[12:15], s20 offen offset:256 nt
    v_dot2c_f32_bf16 v25, v186, v14
    v_dot2c_f32_bf16 v26, v194, v6
    v_dot2c_f32_bf16 v27, v194, v14
    v_dot2c_f32_bf16 v20, v171, v7
    v_dot2c_f32_bf16 v21, v171, v15
    v_dot2c_f32_bf16 v22, v179, v7
    v_dot2c_f32_bf16 v23, v179, v15
    v_dot2c_f32_bf16 v24, v187, v7
    v_dot2c_f32_bf16 v25, v187, v15
    v_dot2c_f32_bf16 v26, v195, v7
    v_dot2c_f32_bf16 v27, v195, v15
    s_waitcnt vmcnt(6)
    s_cbranch_vccnz L_w28
    s_waitcnt vmcnt(4)
L_w28:
    buffer_load_dwordx4 v[148:151], v69, s[12:15], s20 offen offset:256 nt
    v_dot2c_f32_bf16 v20, v172, v8
    v_dot2c_f32_bf16 v21, v172, v16
    v_dot2c_f32_bf16 v22, v180, v8
    v_dot2c_f32_bf16 v23, v180, v16
    v_dot2c_f32_bf16 v24, v188, v8
    v_dot2c_f32_bf16 v25, v188, v16
    v_dot2c_f32_bf16 v26, v196, v8
    v_dot2c_f32_bf16 v27, v196, v16
    v_dot2c_f32_bf16 v20, v173, v9
    v_dot2c_f32_bf16 v21, v173, v17
    v_dot2c_f32_bf16 v22, v181, v9
    s_waitcnt vmcnt(5)
    s_cbranch_vccnz L_w29
    s_waitcnt vmcnt(4)
L_w29:
    buffer_load_dwordx4 v[152:155], v70, s[12:15], s20 offen offset:0 nt
    v_dot2c_f32_bf16 v23, v181, v17
    v_dot2c_f32_bf16 v24, v189, v9
    v_dot2c_f32_bf16 v25, v189, v17
    v_dot2c_f32_bf16 v26, v197, v9
    v_dot2c_f32_bf16 v27, v197, v17
    v_dot2c_f32_bf16 v20, v174, v10
    v_dot2c_f32_bf16 v21, v174, v18
    v_dot2c_f32_bf16 v22, v182, v10
    v_dot2c_f32_bf16 v23, v182, v18
    v_dot2c_f32_bf16 v24, v190, v10
    v_dot2c_f32_bf16 v25, v190, v18
    s_waitcnt vmcnt(6)
    s_cbranch_vccnz L_w30
    s_waitcnt vmcnt(4)
L_w30:
    buffer_load_dwordx4 v[160:163], v71, s[12:15], s20 offen offset:0 nt
    v_dot2c_f32_bf16 v26, v198, v10
    v_dot2c_f32_bf16 v27, v198, v18
    v_dot2c_f32_bf16 v20, v175, v11
    v_dot2c_f32_bf16 v21, v175, v19
    v_dot2c_f32_bf16 v22, v183, v11
    v_dot2c_f32_bf16 v23, v183, v19
    v_dot2c_f32_bf16 v24, v191, v11
    v_dot2c_f32_bf16 v25, v191, v19
    v_dot2c_f32_bf16 v26, v199, v11
    v_dot2c_f32_bf16 v27, v199, v19
    s_waitcnt lgkmcnt(0)
    v_cmp_ne_u32 vcc, 0, v66
    s_waitcnt vmcnt(5)
    s_cbranch_vccnz L_w31
    s_waitcnt vmcnt(4)
L_w31:
    buffer_load_dwordx4 v[156:159], v70, s[12:15], s20 offen offset:256 nt
    v_add_f32_dpp v36, v20, v20 row_ror:8 row_mask:0xf bank_mask:0x3
    v_add_f32_dpp v37, v22, v22 row_ror:8 row_mask:0xf bank_mask:0x3
    v_add_f32_dpp v38, v24, v24 row_ror:8 row_mask:0xf bank_mask:0x3
    v_add_f32_dpp v39, v26, v26 row_ror:8 row_mask:0xf bank_mask:0x3
    v_add_f32_dpp v36, v21, v21 row_ror:8 row_mask:0xf bank_mask:0xc
    v_add_f32_dpp v37, v23, v23 row_ror:8 row_mask:0xf bank_mask:0xc
    v_add_f32_dpp v38, v25, v25 row_ror:8 row_mask:0xf bank_mask:0xc
    v_add_f32_dpp v39, v27, v27 row_ror:8 row_mask:0xf bank_mask:0xc
    v_add_f32_dpp v36, v36, v36 row_half_mirror row_mask:0xf bank_mask:0xf
    v_add_f32_dpp v37, v37, v37 row_half_mirror row_mask:0xf bank_mask:0xf
    v_add_f32_dpp v38, v38, v38 row_half_mirror row_mask:0xf bank_mask:0xf
    s_waitcnt vmcnt(6)
    s_cbranch_vccnz L_w32
    s_waitcnt vmcnt(4)
L_w32:
    buffer_load_dwordx4 v[164:167], v71, s[12:15], s20 offen offset:256 nt
    s_bitcmp1_b32 s7, 0
    s_cselect_b32 s20, 0x80000, 0
    s_xor_b32 s20, s20, s16
    s_bitcmp1_b32 s7, 1
    s_cselect_b32 s17, 0x400, 0
    s_xor_b32 s20, s20, s17
    s_bitcmp1_b32 s7, 2
    s_cselect_b32 s17, 0x1c9c00, 0
    s_xor_b32 s20, s20, s17
    s_bitcmp1_b32 s7, 3
    s_cselect_b32 s17, 0x4000, 0
    s_xor_b32 s20, s20, s17
    s_add_u32 s7, s7, 1
    v_add_f32_dpp v39, v39, v39 row_half_mirror row_mask:0xf bank_mask:0xf
    v_add_f32_dpp v36, v36, v36 quad_perm:[1,0,3,2] row_mask:0xf bank_mask:0xf
    v_add_f32_dpp v37, v37, v37 quad_perm:[1,0,3,2] row_mask:0xf bank_mask:0xf
    v_add_f32_dpp v38, v38, v38 quad_perm:[1,0,3,2] row_mask:0xf bank_mask:0xf
    v_add_f32_dpp v39, v39, v39 quad_perm:[1,0,3,2] row_mask:0xf bank_mask:0xf
    v_add_f32_dpp v36, v36, v36 quad_perm:[2,3,0,1] row_mask:0xf bank_mask:0xf
    v_add_f32_dpp v37, v37, v37 quad_perm:[2,3,0,1] row_mask:0xf bank_mask:0xf
    v_add_f32_dpp v38, v38, v38 quad_perm:[2,3,0,1] row_mask:0xf bank_mask:0xf
    v_add_f32_dpp v39, v39, v39 quad_perm:[2,3,0,1] row_mask:0xf bank_mask:0xf
    v_max3_f32 v60, v60, v36, v37
    v_max3_f32 v60, v60, v38, v39
    s_mov_b64 exec, s[18:19]
    ds_write_b128 v64, v[36:39] offset:1536
    s_mov_b64 exec, -1
    s_mov_b64 exec, 1
    ds_add_u32 v3, v2 offset:12
    s_mov_b64 exec, -1
    v_add_u32 v64, 2048, v64
    s_sub_u32 s21, s21, 1
    s_cmp_lg_u32 s21, 0
    s_cbranch_scc1 L_k0
    v_mov_b32 v63, v60
    v_lshl_add_u32 v62, v0, 2, s50
    v_mov_b32 v64, v61
    v_permlane16_swap_b32 v63, v60
    s_nop 1
    v_max_f32 v60, v60, v63
    v_mov_b32 v63, v60
    s_nop 1
    v_permlane32_swap_b32 v63, v60
    s_nop 1
    v_max_f32 v60, v60, v63
    v_mul_f32 v60, s22, v60
    ds_write_b32 v62, v60
    s_mov_b64 exec, 1
    ds_add_u32 v3, v2 offset:0
    s_mov_b64 exec, -1
    s_add_u32 s23, s23, 64
    s_mov_b32 s21, 4
L_v:
    s_waitcnt vmcnt(5)
    s_cbranch_vccnz L_w33
    s_waitcnt vmcnt(4)
L_w33:
    buffer_load_dwordx4 v[168:171], v68, s[12:15], s20 offen offset:0 nt
    ds_read_b128 v[36:39], v64 offset:0
    ds_read_b32 v66, v3 offset:24
    s_waitcnt vmcnt(6)
    s_cbranch_vccnz L_w34
    s_waitcnt vmcnt(4)
L_w34:
    buffer_load_dwordx4 v[176:179], v69, s[12:15], s20 offen offset:0 nt
    s_waitcnt lgkmcnt(0)
    v_cmp_ne_u32 vcc, 0, v66
    v_fma_f32 v36, v36, s22, -v60
    v_fma_f32 v37, v37, s22, -v60
    v_fma_f32 v38, v38, s22, -v60
    v_fma_f32 v39, v39, s22, -v60
    s_waitcnt vmcnt(5)
    s_cbranch_vccnz L_w35
    s_waitcnt vmcnt(4)
L_w35:
    buffer_load_dwordx4 v[172:175], v68, s[12:15], s20 offen offset:256 nt
    v_exp_f32 v36, v36
    v_exp_f32 v37, v37
    v_exp_f32 v38, v38
    v_exp_f32 v39, v39
    s_nop 0
    v_cvt_pk_bf16_f32 v36, v36, v36
    s_waitcnt vmcnt(6)
    s_cbranch_vccnz L_w36
    s_waitcnt vmcnt(4)
L_w36:
    buffer_load_dwordx4 v[180:183], v69, s[12:15], s20 offen offset:256 nt
    v_cvt_pk_bf16_f32 v37, v37, v37
    v_cvt_pk_bf16_f32 v38, v38, v38
    v_cvt_pk_bf16_f32 v39, v39, v39
    v_and_b32 v40, v36, v56
    v_and_b32 v41, v36, v57
    s_waitcnt vmcnt(5)
    s_cbranch_vccnz L_w37
    s_waitcnt vmcnt(4)
L_w37:
    buffer_load_dwordx4 v[184:187], v70, s[12:15], s20 offen offset:0 nt
    v_and_b32 v42, v36, v58
    v_and_b32 v43, v36, v59
    v_and_b32 v44, v37, v56
    v_and_b32 v45, v37, v57
    v_and_b32 v46, v37, v58
    s_waitcnt vmcnt(6)
    s_cbranch_vccnz L_w38
    s_waitcnt vmcnt(4)
L_w38:
    buffer_load_dwordx4 v[192:195], v71, s[12:15], s20 offen offset:0 nt
    v_and_b32 v47, v37, v59
    v_and_b32 v48, v38, v56
    v_and_b32 v49, v38, v57
    v_and_b32 v50, v38, v58
    v_and_b32 v51, v38, v59
    v_and_b32 v52, v39, v56
    s_waitcnt vmcnt(5)
    s_cbranch_vccnz L_w39
    s_waitcnt vmcnt(4)
L_w39:
    buffer_load_dwordx4 v[188:191], v70, s[12:15], s20 offen offset:256 nt
    v_and_b32 v53, v39, v57
    v_and_b32 v54, v39, v58
    v_and_b32 v55, v39, v59
    v_mfma_f32_16x16x32_bf16 v[28:31], v[72:75], v[40:43], v[28:31]
    v_mfma_f32_16x16x32_bf16 v[32:35], v[76:79], v[40:43], v[32:35]
    s_waitcnt vmcnt(6)
    s_cbranch_vccnz L_w40
    s_waitcnt vmcnt(4)
L_w40:
    buffer_load_dwordx4 v[196:199], v71, s[12:15], s20 offen offset:256 nt
    s_bitcmp1_b32 s7, 0
    s_cselect_b32 s20, 0x80000, 0
    s_xor_b32 s20, s20, s16
    s_bitcmp1_b32 s7, 1
    s_cselect_b32 s17, 0x400, 0
    s_xor_b32 s20, s20, s17
    s_bitcmp1_b32 s7, 2
    s_cselect_b32 s17, 0x1c9c00, 0
    s_xor_b32 s20, s20, s17
    s_bitcmp1_b32 s7, 3
    s_cselect_b32 s17, 0x4000, 0
    s_xor_b32 s20, s20, s17
    s_add_u32 s7, s7, 1
    v_mfma_f32_16x16x32_bf16 v[28:31], v[80:83], v[44:47], v[28:31]
    v_mfma_f32_16x16x32_bf16 v[32:35], v[84:87], v[44:47], v[32:35]
    v_mfma_f32_16x16x32_bf16 v[28:31], v[88:91], v[48:51], v[28:31]
    v_mfma_f32_16x16x32_bf16 v[32:35], v[92:95], v[48:51], v[32:35]
    v_mfma_f32_16x16x32_bf16 v[28:31], v[96:99], v[52:55], v[28:31]
    v_mfma_f32_16x16x32_bf16 v[32:35], v[100:103], v[52:55], v[32:35]
    s_add_u32 s3, s21, s23
    s_cmp_eq_u32 s3, 257
    s_cbranch_scc1 L_drain
    s_cmp_eq_u32 s21, 1
    s_cselect_b64 s[12:13], s[60:61], s[12:13]
    s_waitcnt vmcnt(5)
    s_cbranch_vccnz L_w41
    s_waitcnt vmcnt(4)
L_w41:
    buffer_load_dwordx4 v[72:75], v68, s[12:15], s20 offen offset:0 nt
    ds_read_b128 v[36:39], v64 offset:512
    ds_read_b32 v66, v3 offset:24
    s_waitcnt vmcnt(6)
    s_cbranch_vccnz L_w42
    s_waitcnt vmcnt(4)
L_w42:
    buffer_load_dwordx4 v[80:83], v69, s[12:15], s20 offen offset:0 nt
    s_waitcnt lgkmcnt(0)
    v_cmp_ne_u32 vcc, 0, v66
    v_fma_f32 v36, v36, s22, -v60
    v_fma_f32 v37, v37, s22, -v60
    v_fma_f32 v38, v38, s22, -v60
    v_fma_f32 v39, v39, s22, -v60
    s_waitcnt vmcnt(5)
    s_cbranch_vccnz L_w43
    s_waitcnt vmcnt(4)
L_w43:
    buffer_load_dwordx4 v[76:79], v68, s[12:15], s20 offen offset:256 nt
    v_exp_f32 v36, v36
    v_exp_f32 v37, v37
    v_exp_f32 v38, v38
    v_exp_f32 v39, v39
    s_nop 0
    v_cvt_pk_bf16_f32 v36, v36, v36
    s_waitcnt vmcnt(6)
    s_cbranch_vccnz L_w44
    s_waitcnt vmcnt(4)
L_w44:
    buffer_load_dwordx4 v[84:87], v69, s[12:15], s20 offen offset:256 nt
    v_cvt_pk_bf16_f32 v37, v37, v37
    v_cvt_pk_bf16_f32 v38, v38, v38
    v_cvt_pk_bf16_f32 v39, v39, v39
    v_and_b32 v40, v36, v56
    v_and_b32 v41, v36, v57
    s_waitcnt vmcnt(5)
    s_cbranch_vccnz L_w45
    s_waitcnt vmcnt(4)
L_w45:
    buffer_load_dwordx4 v[88:91], v70, s[12:15], s20 offen offset:0 nt
    v_and_b32 v42, v36, v58
    v_and_b32 v43, v36, v59
    v_and_b32 v44, v37, v56
    v_and_b32 v45, v37, v57
    v_and_b32 v46, v37, v58
    s_waitcnt vmcnt(6)
    s_cbranch_vccnz L_w46
    s_waitcnt vmcnt(4)
L_w46:
    buffer_load_dwordx4 v[96:99], v71, s[12:15], s20 offen offset:0 nt
    v_and_b32 v47, v37, v59
    v_and_b32 v48, v38, v56
    v_and_b32 v49, v38, v57
    v_and_b32 v50, v38, v58
    v_and_b32 v51, v38, v59
    v_and_b32 v52, v39, v56
    s_waitcnt vmcnt(5)
    s_cbranch_vccnz L_w47
    s_waitcnt vmcnt(4)
L_w47:
    buffer_load_dwordx4 v[92:95], v70, s[12:15], s20 offen offset:256 nt
    v_and_b32 v53, v39, v57
    v_and_b32 v54, v39, v58
    v_and_b32 v55, v39, v59
    v_mfma_f32_16x16x32_bf16 v[28:31], v[104:107], v[40:43], v[28:31]
    v_mfma_f32_16x16x32_bf16 v[32:35], v[108:111], v[40:43], v[32:35]
    s_waitcnt vmcnt(6)
    s_cbranch_vccnz L_w48
    s_waitcnt vmcnt(4)
L_w48:
    buffer_load_dwordx4 v[100:103], v71, s[12:15], s20 offen offset:256 nt
    s_bitcmp1_b32 s7, 0
    s_cselect_b32 s20, 0x80000, 0
    s_xor_b32 s20, s20, s16
    s_bitcmp1_b32 s7, 1
    s_cselect_b32 s17, 0x400, 0
    s_xor_b32 s20, s20, s17
    s_bitcmp1_b32 s7, 2
    s_cselect_b32 s17, 0x1c9c00, 0
    s_xor_b32 s20, s20, s17
    s_bitcmp1_b32 s7, 3
    s_cselect_b32 s17, 0x4000, 0
    s_xor_b32 s20, s20, s17
    s_add_u32 s7, s7, 1
    v_mfma_f32_16x16x32_bf16 v[28:31], v[112:115], v[44:47], v[28:31]
    v_mfma_f32_16x16x32_bf16 v[32:35], v[116:119], v[44:47], v[32:35]
    v_mfma_f32_16x16x32_bf16 v[28:31], v[120:123], v[48:51], v[28:31]
    v_mfma_f32_16x16x32_bf16 v[32:35], v[124:127], v[48:51], v[32:35]
    v_mfma_f32_16x16x32_bf16 v[28:31], v[128:131], v[52:55], v[28:31]
    v_mfma_f32_16x16x32_bf16 v[32:35], v[132:135], v[52:55], v[32:35]
    s_mov_b64 exec, 1
    ds_add_u32 v3, v2 offset:16
    s_mov_b64 exec, -1
    s_waitcnt vmcnt(5)
    s_cbranch_vccnz L_w49
    s_waitcnt vmcnt(4)
L_w49:
    buffer_load_dwordx4 v[104:107], v68, s[12:15], s20 offen offset:0 nt
    ds_read_b128 v[36:39], v64 offset:1024
    ds_read_b32 v66, v3 offset:24
    s_waitcnt vmcnt(6)
    s_cbranch_vccnz L_w50
    s_waitcnt vmcnt(4)
L_w50:
    buffer_load_dwordx4 v[112:115], v69, s[12:15], s20 offen offset:0 nt
    s_waitcnt lgkmcnt(0)
    v_cmp_ne_u32 vcc, 0, v66
    v_fma_f32 v36, v36, s22, -v60
    v_fma_f32 v37, v37, s22, -v60
    v_fma_f32 v38, v38, s22, -v60
    v_fma_f32 v39, v39, s22, -v60
    s_waitcnt vmcnt(5)
    s_cbranch_vccnz L_w51
    s_waitcnt vmcnt(4)
L_w51:
    buffer_load_dwordx4 v[108:111], v68, s[12:15], s20 offen offset:256 nt
    v_exp_f32 v36, v36
    v_exp_f32 v37, v37
    v_exp_f32 v38, v38
    v_exp_f32 v39, v39
    s_nop 0
    v_cvt_pk_bf16_f32 v36, v36, v36
    s_waitcnt vmcnt(6)
    s_cbranch_vccnz L_w52
    s_waitcnt vmcnt(4)
L_w52:
    buffer_load_dwordx4 v[116:119], v69, s[12:15], s20 offen offset:256 nt
    v_cvt_pk_bf16_f32 v37, v37, v37
    v_cvt_pk_bf16_f32 v38, v38, v38
    v_cvt_pk_bf16_f32 v39, v39, v39
    v_and_b32 v40, v36, v56
    v_and_b32 v41, v36, v57
    s_waitcnt vmcnt(5)
    s_cbranch_vccnz L_w53
    s_waitcnt vmcnt(4)
L_w53:
    buffer_load_dwordx4 v[120:123], v70, s[12:15], s20 offen offset:0 nt
    v_and_b32 v42, v36, v58
    v_and_b32 v43, v36, v59
    v_and_b32 v44, v37, v56
    v_and_b32 v45, v37, v57
    v_and_b32 v46, v37, v58
    s_waitcnt vmcnt(6)
    s_cbranch_vccnz L_w54
    s_waitcnt vmcnt(4)
L_w54:
    buffer_load_dwordx4 v[128:131], v71, s[12:15], s20 offen offset:0 nt
    v_and_b32 v47, v37, v59
    v_and_b32 v48, v38, v56
    v_and_b32 v49, v38, v57
    v_and_b32 v50, v38, v58
    v_and_b32 v51, v38, v59
    v_and_b32 v52, v39, v56
    s_waitcnt vmcnt(5)
    s_cbranch_vccnz L_w55
    s_waitcnt vmcnt(4)
L_w55:
    buffer_load_dwordx4 v[124:127], v70, s[12:15], s20 offen offset:256 nt
    v_and_b32 v53, v39, v57
    v_and_b32 v54, v39, v58
    v_and_b32 v55, v39, v59
    v_mfma_f32_16x16x32_bf16 v[28:31], v[136:139], v[40:43], v[28:31]
    v_mfma_f32_16x16x32_bf16 v[32:35], v[140:143], v[40:43], v[32:35]
    s_waitcnt vmcnt(6)
    s_cbranch_vccnz L_w56
    s_waitcnt vmcnt(4)
L_w56:
    buffer_load_dwordx4 v[132:135], v71, s[12:15], s20 offen offset:256 nt
    s_bitcmp1_b32 s7, 0
    s_cselect_b32 s20, 0x80000, 0
    s_xor_b32 s20, s20, s16
    s_bitcmp1_b32 s7, 1
    s_cselect_b32 s17, 0x400, 0
    s_xor_b32 s20, s20, s17
    s_bitcmp1_b32 s7, 2
    s_cselect_b32 s17, 0x1c9c00, 0
    s_xor_b32 s20, s20, s17
    s_bitcmp1_b32 s7, 3
    s_cselect_b32 s17, 0x4000, 0
    s_xor_b32 s20, s20, s17
    s_add_u32 s7, s7, 1
    v_mfma_f32_16x16x32_bf16 v[28:31], v[144:147], v[44:47], v[28:31]
    v_mfma_f32_16x16x32_bf16 v[32:35], v[148:151], v[44:47], v[32:35]
    v_mfma_f32_16x16x32_bf16 v[28:31], v[152:155], v[48:51], v[28:31]
    v_mfma_f32_16x16x32_bf16 v[32:35], v[156:159], v[48:51], v[32:35]
    v_mfma_f32_16x16x32_bf16 v[28:31], v[160:163], v[52:55], v[28:31]
    v_mfma_f32_16x16x32_bf16 v[32:35], v[164:167], v[52:55], v[32:35]
    s_waitcnt vmcnt(5)
    s_cbranch_vccnz L_w57
    s_waitcnt vmcnt(4)
L_w57:
    buffer_load_dwordx4 v[136:139], v68, s[12:15], s20 offen offset:0 nt
    ds_read_b128 v[36:39], v64 offset:1536
    ds_read_b32 v66, v3 offset:24
    s_waitcnt vmcnt(6)
    s_cbranch_vccnz L_w58
    s_waitcnt vmcnt(4)
L_w58:
    buffer_load_dwordx4 v[144:147], v69, s[12:15], s20 offen offset:0 nt
    s_waitcnt lgkmcnt(0)
    v_cmp_ne_u32 vcc, 0, v66
    v_fma_f32 v36, v36, s22, -v60
    v_fma_f32 v37, v37, s22, -v60
    v_fma_f32 v38, v38, s22, -v60
    v_fma_f32 v39, v39, s22, -v60
    s_waitcnt vmcnt(5)
    s_cbranch_vccnz L_w59
    s_waitcnt vmcnt(4)
L_w59:
    buffer_load_dwordx4 v[140:143], v68, s[12:15], s20 offen offset:256 nt
    v_exp_f32 v36, v36
    v_exp_f32 v37, v37
    v_exp_f32 v38, v38
    v_exp_f32 v39, v39
    s_nop 0
    v_cvt_pk_bf16_f32 v36, v36, v36
    s_waitcnt vmcnt(6)
    s_cbranch_vccnz L_w60
    s_waitcnt vmcnt(4)
L_w60:
    buffer_load_dwordx4 v[148:151], v69, s[12:15], s20 offen offset:256 nt
    v_cvt_pk_bf16_f32 v37, v37, v37
    v_cvt_pk_bf16_f32 v38, v38, v38
    v_cvt_pk_bf16_f32 v39, v39, v39
    v_and_b32 v40, v36, v56
    v_and_b32 v41, v36, v57
    s_waitcnt vmcnt(5)
    s_cbranch_vccnz L_w61
    s_waitcnt vmcnt(4)
L_w61:
    buffer_load_dwordx4 v[152:155], v70, s[12:15], s20 offen offset:0 nt
    v_and_b32 v42, v36, v58
    v_and_b32 v43, v36, v59
    v_and_b32 v44, v37, v56
    v_and_b32 v45, v37, v57
    v_and_b32 v46, v37, v58
    s_waitcnt vmcnt(6)
    s_cbranch_vccnz L_w62
    s_waitcnt vmcnt(4)
L_w62:
    buffer_load_dwordx4 v[160:163], v71, s[12:15], s20 offen offset:0 nt
    v_and_b32 v47, v37, v59
    v_and_b32 v48, v38, v56
    v_and_b32 v49, v38, v57
    v_and_b32 v50, v38, v58
    v_and_b32 v51, v38, v59
    v_and_b32 v52, v39, v56
    s_waitcnt vmcnt(5)
    s_cbranch_vccnz L_w63
    s_waitcnt vmcnt(4)
L_w63:
    buffer_load_dwordx4 v[156:159], v70, s[12:15], s20 offen offset:256 nt
    v_and_b32 v53, v39, v57
    v_and_b32 v54, v39, v58
    v_and_b32 v55, v39, v59
    v_mfma_f32_16x16x32_bf16 v[28:31], v[168:171], v[40:43], v[28:31]
    v_mfma_f32_16x16x32_bf16 v[32:35], v[172:175], v[40:43], v[32:35]
    s_waitcnt vmcnt(6)
    s_cbranch_vccnz L_w64
    s_waitcnt vmcnt(4)
L_w64:
    buffer_load_dwordx4 v[164:167], v71, s[12:15], s20 offen offset:256 nt
    s_bitcmp1_b32 s7, 0
    s_cselect_b32 s20, 0x80000, 0
    s_xor_b32 s20, s20, s16
    s_bitcmp1_b32 s7, 1
    s_cselect_b32 s17, 0x400, 0
    s_xor_b32 s20, s20, s17
    s_bitcmp1_b32 s7, 2
    s_cselect_b32 s17, 0x1c9c00, 0
    s_xor_b32 s20, s20, s17
    s_bitcmp1_b32 s7, 3
    s_cselect_b32 s17, 0x4000, 0
    s_xor_b32 s20, s20, s17
    s_add_u32 s7, s7, 1
    v_mfma_f32_16x16x32_bf16 v[28:31], v[176:179], v[44:47], v[28:31]
    v_mfma_f32_16x16x32_bf16 v[32:35], v[180:183], v[44:47], v[32:35]
    v_mfma_f32_16x16x32_bf16 v[28:31], v[184:187], v[48:51], v[28:31]
    v_mfma_f32_16x16x32_bf16 v[32:35], v[188:191], v[48:51], v[32:35]
    v_mfma_f32_16x16x32_bf16 v[28:31], v[192:195], v[52:55], v[28:31]
    v_mfma_f32_16x16x32_bf16 v[32:35], v[196:199], v[52:55], v[32:35]
    s_mov_b64 exec, 1
    ds_add_u32 v3, v2 offset:12
    s_mov_b64 exec, -1
    v_add_u32 v64, 2048, v64
    s_sub_u32 s21, s21, 1
    s_cmp_lg_u32 s21, 0
    s_cbranch_scc1 L_v
    v_lshl_add_u32 v62, v0, 4, s51
    s_mov_b32 s5, 0x400000
    s_mov_b64 s[58:59], s[62:63]
    v_add_u32 v61, 8192, v61
    s_add_u32 s50, s50, 1024
    s_add_u32 s51, s51, 8192
    ds_write_b128 v62, v[28:31]
    ds_write_b128 v62, v[32:35] offset:1024
    s_mov_b64 exec, 1
    ds_add_u32 v3, v2 offset:4
    s_mov_b64 exec, -1
    s_add_u32 s23, s23, 64
L_wq:
    ds_read_b32 v62, v3 offset:8
    s_waitcnt lgkmcnt(0)
    v_readfirstlane_b32 s3, v62
    s_nop 3
    s_cmp_lg_u32 s3, 0
    s_cbranch_scc1 L_newp
    s_sleep 2
    s_sub_u32 s5, s5, 1
    s_cmp_lg_u32 s5, 0
    s_cbranch_scc1 L_wq
    s_branch L_newp
L_drain:
    s_mov_b64 exec, 1
    ds_add_u32 v3, v2 offset:12
    s_mov_b64 exec, -1
    v_lshl_add_u32 v62, v0, 4, s51
    ds_read_b128 v[36:39], v64 offset:512
    s_waitcnt lgkmcnt(0)
    v_fma_f32 v36, v36, s22, -v60
    v_fma_f32 v37, v37, s22, -v60
    v_fma_f32 v38, v38, s22, -v60
    v_fma_f32 v39, v39, s22, -v60
    v_exp_f32 v36, v36
    v_exp_f32 v37, v37
    v_exp_f32 v38, v38
    v_exp_f32 v39, v39
    s_nop 0
    v_cvt_pk_bf16_f32 v36, v36, v36
    v_cvt_pk_bf16_f32 v37, v37, v37
    v_cvt_pk_bf16_f32 v38, v38, v38
    v_cvt_pk_bf16_f32 v39, v39, v39
    v_and_b32 v40, v36, v56
    v_and_b32 v41, v36, v57
    v_and_b32 v42, v36, v58
    v_and_b32 v43, v36, v59
    v_and_b32 v44, v37, v56
    v_and_b32 v45, v37, v57
    v_and_b32 v46, v37, v58
    v_and_b32 v47, v37, v59
    v_and_b32 v48, v38, v56
    v_and_b32 v49, v38, v57
    v_and_b32 v50, v38, v58
    v_and_b32 v51, v38, v59
    v_and_b32 v52, v39, v56
    v_and_b32 v53, v39, v57
    v_and_b32 v54, v39, v58
    v_and_b32 v55, v39, v59
    s_waitcnt vmcnt(16)
    v_mfma_f32_16x16x32_bf16 v[28:31], v[104:107], v[40:43], v[28:31]
    v_mfma_f32_16x16x32_bf16 v[32:35], v[108:111], v[40:43], v[32:35]
    v_mfma_f32_16x16x32_bf16 v[28:31], v[112:115], v[44:47], v[28:31]
    v_mfma_f32_16x16x32_bf16 v[32:35], v[116:119], v[44:47], v[32:35]
    v_mfma_f32_16x16x32_bf16 v[28:31], v[120:123], v[48:51], v[28:31]
    v_mfma_f32_16x16x32_bf16 v[32:35], v[124:127], v[48:51], v[32:35]
    v_mfma_f32_16x16x32_bf16 v[28:31], v[128:131], v[52:55], v[28:31]
    v_mfma_f32_16x16x32_bf16 v[32:35], v[132:135], v[52:55], v[32:35]
    ds_read_b128 v[36:39], v64 offset:1024
    s_waitcnt lgkmcnt(0)
    v_fma_f32 v36, v36, s22, -v60
    v_fma_f32 v37, v37, s22, -v60
    v_fma_f32 v38, v38, s22, -v60
    v_fma_f32 v39, v39, s22, -v60
    v_exp_f32 v36, v36
    v_exp_f32 v37, v37
    v_exp_f32 v38, v38
    v_exp_f32 v39, v39
    s_nop 0
    v_cvt_pk_bf16_f32 v36, v36, v36
    v_cvt_pk_bf16_f32 v37, v37, v37
    v_cvt_pk_bf16_f32 v38, v38, v38
    v_cvt_pk_bf16_f32 v39, v39, v39
    v_and_b32 v40, v36, v56
    v_and_b32 v41, v36, v57
    v_and_b32 v42, v36, v58
    v_and_b32 v43, v36, v59
    v_and_b32 v44, v37, v56
    v_and_b32 v45, v37, v57
    v_and_b32 v46, v37, v58
    v_and_b32 v47, v37, v59
    v_and_b32 v48, v38, v56
    v_and_b32 v49, v38, v57
    v_and_b32 v50, v38, v58
    v_and_b32 v51, v38, v59
    v_and_b32 v52, v39, v56
    v_and_b32 v53, v39, v57
    v_and_b32 v54, v39, v58
    v_and_b32 v55, v39, v59
    s_waitcnt vmcnt(8)
    v_mfma_f32_16x16x32_bf16 v[28:31], v[136:139], v[40:43], v[28:31]
    v_mfma_f32_16x16x32_bf16 v[32:35], v[140:143], v[40:43], v[32:35]
    v_mfma_f32_16x16x32_bf16 v[28:31], v[144:147], v[44:47], v[28:31]
    v_mfma_f32_16x16x32_bf16 v[32:35], v[148:151], v[44:47], v[32:35]
    v_mfma_f32_16x16x32_bf16 v[28:31], v[152:155], v[48:51], v[28:31]
    v_mfma_f32_16x16x32_bf16 v[32:35], v[156:159], v[48:51], v[32:35]
    v_mfma_f32_16x16x32_bf16 v[28:31], v[160:163], v[52:55], v[28:31]
    v_mfma_f32_16x16x32_bf16 v[32:35], v[164:167], v[52:55], v[32:35]
    ds_read_b128 v[36:39], v64 offset:1536
    s_waitcnt lgkmcnt(0)
    v_fma_f32 v36, v36, s22, -v60
    v_fma_f32 v37, v37, s22, -v60
    v_fma_f32 v38, v38, s22, -v60
    v_fma_f32 v39, v39, s22, -v60
    v_exp_f32 v36, v36
    v_exp_f32 v37, v37
    v_exp_f32 v38, v38
    v_exp_f32 v39, v39
    s_nop 0
    v_cvt_pk_bf16_f32 v36, v36, v36
    v_cvt_pk_bf16_f32 v37, v37, v37
    v_cvt_pk_bf16_f32 v38, v38, v38
    v_cvt_pk_bf16_f32 v39, v39, v39
    v_and_b32 v40, v36, v56
    v_and_b32 v41, v36, v57
    v_and_b32 v42, v36, v58
    v_and_b32 v43, v36, v59
    v_and_b32 v44, v37, v56
    v_and_b32 v45, v37, v57
    v_and_b32 v46, v37, v58
    v_and_b32 v47, v37, v59
    v_and_b32 v48, v38, v56
    v_and_b32 v49, v38, v57
    v_and_b32 v50, v38, v58
    v_and_b32 v51, v38, v59
    v_and_b32 v52, v39, v56
    v_and_b32 v53, v39, v57
    v_and_b32 v54, v39, v58
    v_and_b32 v55, v39, v59
    s_waitcnt vmcnt(5)
    v_mfma_f32_16x16x32_bf16 v[28:31], v[168:171], v[40:43], v[28:31]
    v_mfma_f32_16x16x32_bf16 v[32:35], v[172:175], v[40:43], v[32:35]
    s_waitcnt vmcnt(4)
    v_mfma_f32_16x16x32_bf16 v[28:31], v[176:179], v[44:47], v[28:31]
    v_mfma_f32_16x16x32_bf16 v[32:35], v[180:183], v[44:47], v[32:35]
    s_waitcnt vmcnt(1)
    v_mfma_f32_16x16x32_bf16 v[28:31], v[184:187], v[48:51], v[28:31]
    v_mfma_f32_16x16x32_bf16 v[32:35], v[188:191], v[48:51], v[32:35]
    s_waitcnt vmcnt(0)
    v_mfma_f32_16x16x32_bf16 v[28:31], v[192:195], v[52:55], v[28:31]
    v_mfma_f32_16x16x32_bf16 v[32:35], v[196:199], v[52:55], v[32:35]
    s_nop 6
    ds_write_b128 v62, v[28:31]
    ds_write_b128 v62, v[32:35] offset:1024
    s_waitcnt lgkmcnt(0)
    s_barrier
    s_cmp_lg_u32 s44, 1
    s_cbranch_scc1 L_send
    s_cmp_ge_u32 s41, 28
    s_cbranch_scc1 L_send
    s_mov_b32 m0, 28672
    s_nop 0
    buffer_load_dwordx4 v248, s[28:31], s48 offen nt lds
    s_mov_b32 m0, 29696
    s_add_u32 s48, s48, 7168
    buffer_load_dwordx4 v249, s[28:31], s48 offen nt lds
    s_mov_b32 m0, 30720
    s_add_u32 s48, s48, 7168
    buffer_load_dwordx4 v250, s[28:31], s48 offen nt lds
    s_mov_b32 m0, 31744
    s_add_u32 s48, s48, 7168
    buffer_load_dwordx4 v251, s[28:31], s48 offen nt lds
    s_mov_b32 m0, 32768
    s_add_u32 s48, s48, 7168
    buffer_load_dwordx4 v248, s[28:31], s48 offen nt lds
    s_mov_b32 m0, 33792
    s_add_u32 s48, s48, 7168
    buffer_load_dwordx4 v249, s[28:31], s48 offen nt lds
    s_mov_b32 m0, 34816
    s_add_u32 s48, s48, 7168
    buffer_load_dwordx4 v250, s[28:31], s48 offen nt lds
    s_mov_b32 m0, 35840
    s_add_u32 s48, s48, 7168
    buffer_load_dwordx4 v251, s[28:31], s48 offen nt lds
    s_mov_b32 m0, 36864
    s_add_u32 s48, s48, 64512
    buffer_load_dwordx4 v248, s[28:31], s48 offen nt lds
    s_mov_b32 m0, 37888
    s_add_u32 s48, s48, 7168
    buffer_load_dwordx4 v249, s[28:31], s48 offen nt lds
    s_mov_b32 m0, 38912
    s_add_u32 s48, s48, 7168
    buffer_load_dwordx4 v250, s[28:31], s48 offen nt lds
    s_mov_b32 m0, 39936
    s_add_u32 s48, s48, 7168
    buffer_load_dwordx4 v251, s[28:31], s48 offen nt lds
    s_mov_b32 m0, 40960
    s_add_u32 s48, s48, 7168
    buffer_load_dwordx4 v248, s[28:31], s48 offen nt lds
    s_mov_b32 m0, 41984
    s_add_u32 s48, s48, 7168
    buffer_load_dwordx4 v249, s[28:31], s48 offen nt lds
    s_mov_b32 m0, 43008
    s_add_u32 s48, s48, 7168
    buffer_load_dwordx4 v250, s[28:31], s48 offen nt lds
    s_mov_b32 m0, 44032
    s_add_u32 s48, s48, 7168
    buffer_load_dwordx4 v251, s[28:31], s48 offen nt lds
    ds_read_b64 v[10:11], v3 offset:32
    s_mov_b64 s[20:21], s[66:67]
    s_mov_b32 s22, 0x300000
    s_mov_b32 s23, 0x20000
    v_and_b32 v2, 15, v0
    v_lshrrev_b32 v3, 4, v0
    v_lshrrev_b32 v22, 1, v2
    v_and_b32 v23, 1, v2
    v_lshl_add_u32 v20, v22, 2, v23
    v_lshlrev_b32 v20, 10, v20
    v_lshl_add_u32 v20, v3, 4, v20
    s_lshl_b32 s58, s43, 15
    s_lshl_b32 s3, s54, 8
    s_add_u32 s58, s58, s3
    s_add_u32 s58, s58, 0x120000
    v_lshl_add_u32 v26, v23, 2, v3
    v_lshlrev_b32 v26, 4, v26
    v_lshl_add_u32 v22, v22, 13, v26
    v_cmp_eq_u32 s[36:37], 1, v23
    s_lshl_b32 s59, s55, 16
    s_lshl_b32 s3, s43, 2
    s_add_u32 s3, s3, s54
    s_lshl_b32 s3, s3, 7
    s_add_u32 s59, s59, s3
    s_add_u32 s59, s59, 0x200000
    s_add_u32 s65, s59, 0x1000
    v_lshrrev_b32 v45, 2, v2
    v_lshl_add_u32 v44, v45, 3, v3
    v_lshlrev_b32 v44, 7, v44
    v_lshl_add_u32 v44, v45, 5, v44
    v_and_b32 v45, 3, v0
    v_lshl_add_u32 v164, v45, 3, v44
    v_xor_b32 v165, 32, v164
    v_xor_b32 v166, 64, v164
    v_xor_b32 v167, 96, v164
    s_mov_b32 s39, 0
    s_mov_b32 s63, 0x40000
    buffer_load_dwordx4 v[112:115], v20, s[20:23], s58 offen offset:0 sc1
    buffer_load_dwordx4 v[116:119], v20, s[20:23], s58 offen offset:64 sc1
    buffer_load_dwordx4 v[120:123], v20, s[20:23], s58 offen offset:128 sc1
    buffer_load_dwordx4 v[124:127], v20, s[20:23], s58 offen offset:192 sc1
    buffer_load_dwordx4 v[128:131], v20, s[20:23], s58 offen offset:2048 sc1
    buffer_load_dwordx4 v[132:135], v20, s[20:23], s58 offen offset:2112 sc1
    buffer_load_dwordx4 v[136:139], v20, s[20:23], s58 offen offset:2176 sc1
    buffer_load_dwordx4 v[140:143], v20, s[20:23], s58 offen offset:2240 sc1
    s_waitcnt lgkmcnt(0)
    v_mov_b32 v97, v10
    v_mov_b32 v99, v11
    v_mov_b32 v101, v10
    v_mov_b32 v103, v11
    s_waitcnt vmcnt(8)
    ds_read_b64_tr_b16 v[192:193], v164 offset:28672
    ds_read_b64_tr_b16 v[194:195], v164 offset:36864
    ds_read_b64_tr_b16 v[196:197], v165 offset:28672
    ds_read_b64_tr_b16 v[198:199], v165 offset:36864
    ds_read_b64_tr_b16 v[200:201], v166 offset:28672
    ds_read_b64_tr_b16 v[202:203], v166 offset:36864
    ds_read_b64_tr_b16 v[204:205], v167 offset:28672
    ds_read_b64_tr_b16 v[206:207], v167 offset:36864
    ds_read_b64_tr_b16 v[208:209], v164 offset:29184
    ds_read_b64_tr_b16 v[210:211], v164 offset:37376
    ds_read_b64_tr_b16 v[212:213], v165 offset:29184
    ds_read_b64_tr_b16 v[214:215], v165 offset:37376
    ds_read_b64_tr_b16 v[216:217], v166 offset:29184
    ds_read_b64_tr_b16 v[218:219], v166 offset:37376
    s_waitcnt lgkmcnt(12)
    ds_read_b64_tr_b16 v[220:221], v167 offset:29184
    ds_read_b64_tr_b16 v[222:223], v167 offset:37376
    s_waitcnt lgkmcnt(7)
    ds_read_b64_tr_b16 v[224:225], v164 offset:32768
    ds_read_b64_tr_b16 v[226:227], v164 offset:40960
    ds_read_b64_tr_b16 v[228:229], v165 offset:32768
    ds_read_b64_tr_b16 v[230:231], v165 offset:40960
    ds_read_b64_tr_b16 v[232:233], v166 offset:32768
    ds_read_b64_tr_b16 v[234:235], v166 offset:40960
    ds_read_b64_tr_b16 v[236:237], v167 offset:32768
    ds_read_b64_tr_b16 v[238:239], v167 offset:40960
    s_waitcnt lgkmcnt(7)
    ds_read_b64_tr_b16 v[240:241], v164 offset:33280
    ds_read_b64_tr_b16 v[242:243], v164 offset:41472
    ds_read_b64_tr_b16 v[244:245], v165 offset:33280
    ds_read_b64_tr_b16 v[246:247], v165 offset:41472
    ds_read_b64_tr_b16 v[248:249], v166 offset:33280
    ds_read_b64_tr_b16 v[250:251], v166 offset:41472
    ds_read_b64_tr_b16 v[252:253], v167 offset:33280
    ds_read_b64_tr_b16 v[254:255], v167 offset:41472
    s_waitcnt lgkmcnt(0)
    s_branch L_chk1
L_send:
    s_endpgm
.section .rodata,"a"
.p2align 6
.amdhsa_kernel concat_heads__gqa_block_cached__gqa_block_cached__decode_kernel
  .amdhsa_next_free_vgpr 256
  .amdhsa_next_free_sgpr 72
  .amdhsa_accum_offset 256
  .amdhsa_group_segment_fixed_size 0
  .amdhsa_kernarg_size 104
  .amdhsa_user_sgpr_count 2
  .amdhsa_user_sgpr_kernarg_segment_ptr 1
  .amdhsa_system_sgpr_workgroup_id_x 1
  .amdhsa_float_denorm_mode_32 3
.end_amdhsa_kernel
```
